```python
import torch

def _softmax(x, axis=-1):
    return torch.softmax(x, dim=axis)
def _gelu(x):
    return torch.nn.functional.gelu(x, approximate="tanh")
def _silu(x):
    return torch.nn.functional.silu(x)
def _sigmoid(x):
    return torch.sigmoid(x)
def _layernorm(x, axis=-1, eps=1e-5):
    m = x.mean(dim=axis, keepdim=True)
    v = x.var(dim=axis, keepdim=True, unbiased=False)
    return (x - m) / torch.sqrt(v + eps)
def _scatter_add(tgt, idx, src, axis=0):
    return tgt.clone().index_add_(axis, idx, src)
def _segment_sum(src, seg, n):
    out = torch.zeros((n,) + src.shape[1:], dtype=src.dtype)
    return out.index_add_(0, seg, src)
def _pad(x, pw):
    flat = tuple(v for pair in reversed(pw) for v in pair)
    return torch.nn.functional.pad(x, flat)

kernel_name = 'interleave_layers__gqa_block_cached__glu_gated_bilinear__decode'

def setup_inputs():

    _w = (lambda a: (lambda t: t.to(torch.bfloat16) if t.is_floating_point() else t)(torch.as_tensor(a)))
    def _A_setup():
        B, Sq, D = 4, 1, 512
        Hq, Hkv, Sk, Dh = 32, 8, 8192, 128
        assert Hq % Hkv == 0, (Hq, Hkv)
        return {
            "x": _w((lambda *s: torch.randn(*s, dtype=torch.bfloat16) * 0.05)(B, Sq, D)),
            "k_cache": _w((lambda *s: torch.randn(*s, dtype=torch.bfloat16) * 1.6)(B, Hkv, Sk, Dh)),
            "v_cache": _w((lambda *s: torch.randn(*s, dtype=torch.bfloat16) * 0.8)(B, Hkv, Sk, Dh)),
            "wq": _w((lambda *s: torch.randn(*s, dtype=torch.bfloat16) * 1.6)(D, Hq * Dh) * (D ** -0.5)),
            "wo": _w((lambda *s: torch.randn(*s, dtype=torch.bfloat16) * 0.8)(Hq * Dh, D) * ((Hq * Dh) ** -0.5)),
        }
    _A_in = _A_setup()

    def _B_setup():
        B, S, D, F = 4, 1, 512, 1792
        return {
            "x": _w((lambda *s: torch.randn(*s, dtype=torch.bfloat16) * 0.05)(B, S, D)),
            "w_gate": _w((lambda *s: torch.randn(*s, dtype=torch.bfloat16) * 0.4)(D, F) * (D ** -0.5)),
            "w_up": _w((lambda *s: torch.randn(*s, dtype=torch.bfloat16) * 0.4)(D, F) * (D ** -0.5)),
            "w_down": _w((lambda *s: torch.randn(*s, dtype=torch.bfloat16) * 0.4)(F, D) * (F ** -0.5)),
        }
    _B_in = _B_setup()

    return {
        "A_x": _A_in["x"],
        "A_k_cache": _A_in["k_cache"],
        "A_v_cache": _A_in["v_cache"],
        "A_wq": _A_in["wq"],
        "A_wo": _A_in["wo"],
        "B_x": _B_in["x"],
        "B_w_gate": _B_in["w_gate"],
        "B_w_up": _B_in["w_up"],
        "B_w_down": _B_in["w_down"],
    }

def reference(A_x, A_k_cache, A_v_cache, A_wq, A_wo, B_x, B_w_gate, B_w_up, B_w_down):
    def _A_ref(x, k_cache, v_cache, wq, wo):
        B, Sq, D = x.shape
        Hq, Dh = 32, 128
        Hkv = k_cache.shape[1]
        rep = Hq // Hkv
        q = (lambda x, *d: x.permute(*d))((x @ wq).reshape(B, Sq, Hq, Dh), 0, 2, 1, 3)
        k = (lambda x, n, axis: torch.repeat_interleave(x, n, dim=axis))(k_cache, rep, axis=1)
        v = (lambda x, n, axis: torch.repeat_interleave(x, n, dim=axis))(v_cache, rep, axis=1)
        scores = torch.einsum("bhqd,bhkd->bhqk", q, k) * (Dh ** -0.5)
        p = _softmax(scores, axis=-1)
        o = torch.einsum("bhqk,bhkd->bhqd", p, v)
        return (lambda x, *d: x.permute(*d))(o, 0, 2, 1, 3).reshape(B, Sq, Hq * Dh) @ wo

    def _B_ref(x, w_gate, w_up, w_down):
        g = torch.einsum("bsd,df->bsf", x, w_gate)
        u = torch.einsum("bsd,df->bsf", x, w_up)
        h = g * u
        return torch.einsum("bsf,fd->bsd", h, w_down)

    x = A_x
    x = x + _A_ref(_layernorm(x, axis=-1), A_k_cache, A_v_cache, A_wq, A_wo)
    x = x + _B_ref(_layernorm(x, axis=-1), B_w_gate, B_w_up, B_w_down)
    x = x + _A_ref(_layernorm(x, axis=-1), A_k_cache, A_v_cache, A_wq, A_wo)
    x = x + _B_ref(_layernorm(x, axis=-1), B_w_gate, B_w_up, B_w_down)
    return x
```

```asm
; @launch grid=(256,1,1) block=(256,1,1) lds=163840
.amdgcn_target "amdgcn-amd-amdhsa--gfx950"
.text
.globl interleave_layers__gqa_block_cached__glu_gated_bilinear__decode_kernel
.p2align 8
.type interleave_layers__gqa_block_cached__glu_gated_bilinear__decode_kernel,@function
interleave_layers__gqa_block_cached__glu_gated_bilinear__decode_kernel:
    s_load_dwordx16 s[4:19], s[0:1], 0
    s_load_dwordx8 s[20:27], s[0:1], 64
    v_lshrrev_b32 v1, 6, v0
    s_cmpk_ge_u32 s2, 256
    v_readfirstlane_b32 s60, v1
    s_cbranch_scc1 L_end
    v_and_b32 v0, 63, v0
    s_and_b32 s61, s2, 7
    s_lshr_b32 s62, s2, 3
    s_lshr_b32 s63, s2, 6
    s_and_b32 s64, s62, 7
    s_lshl2_add_u32 s65, s64, s60
    s_lshl3_add_u32 s100, s63, s61
    s_lshl_b32 s100, s100, 21
    s_mul_i32 s66, s60, 24576
    s_lshl_b32 s65, s65, 12
    s_lshl2_add_u32 s67, s63, s61
    s_and_b32 s67, s67, 15
    s_lshl_b32 s67, s67, 17
    v_lshrrev_b32 v5, 4, v0
    v_and_b32 v6, 15, v0
    v_xor_b32 v7, v5, v6
    v_lshlrev_b32 v7, 4, v7
    v_lshl_add_u32 v240, v5, 8, v7
    v_xor_b32 v241, 64, v240
    v_xor_b32 v242, 128, v240
    v_xor_b32 v243, 64, v242
    s_lshl_b32 s98, s2, 10
    s_bitset1_b32 s98, 22
    v_mov_b32 v9, s98
    v_xor_b32 v10, 0x2000, v9
    s_lshl_b32 s30, 1, 21
    s_mov_b32 s31, 0x20000
    s_or_b32 s68, s67, s65
    s_add_u32 m0, s66, 0
    s_waitcnt lgkmcnt(0)
    global_load_dword v123, v9, s[26:27] sc1
    global_load_dword v123, v10, s[26:27] offset:128 sc1
    s_add_u32 s28, s6, s100
    s_addc_u32 s29, s7, 0
    buffer_load_dwordx4 v240, s[28:31], s68 offen offset:0 nt lds
    buffer_load_dwordx4 v241, s[28:31], s68 offen offset:1024 nt lds
    buffer_load_dwordx4 v242, s[28:31], s68 offen offset:2048 nt lds
    buffer_load_dwordx4 v243, s[28:31], s68 offen offset:3072 nt lds
    s_cmp_eq_u32 s60, 0
    s_cbranch_scc0 L_novote
    s_waitcnt vmcnt(5)
L_novote:
    s_add_u32 s32, s8, s100
    s_addc_u32 s33, s9, 0
    s_mov_b32 s34, s30
    s_getreg_b32 s99, hwreg(HW_REG_IB_STS, 0, 4)
L_entered:
    s_add_u32 s67, s67, 0x20000
    s_and_b32 s67, s67, 0x1e0000
    s_or_b32 s68, s67, s65
    s_add_u32 m0, s66, 4096
    s_nop 0
    buffer_load_dwordx4 v240, s[28:31], s68 offen offset:0 nt lds
    buffer_load_dwordx4 v241, s[28:31], s68 offen offset:1024 nt lds
    buffer_load_dwordx4 v242, s[28:31], s68 offen offset:2048 nt lds
    buffer_load_dwordx4 v243, s[28:31], s68 offen offset:3072 nt lds
    s_mov_b32 s35, 0x20000
    v_lshl_add_u32 v244, v6, 8, v7
    v_add_u32 v244, s66, v244
    v_xor_b32 v245, 64, v244
    v_xor_b32 v246, 128, v244
    v_xor_b32 v247, 192, v244
    v_lshlrev_b32_e64 v1, 4, v0
    s_mov_b32 s52, s24
    s_mov_b32 s53, s25
    s_mov_b32 s54, 256
    s_mov_b32 s55, 0x20000
    s_mov_b32 s36, s26
    s_mov_b32 s37, s27
    s_mov_b32 s38, 0x300000
    s_mov_b32 s39, 0x20000
    s_mov_b32 s48, s22
    s_mov_b32 s49, s23
    s_mov_b32 s50, 4096
    s_mov_b32 s51, 0x20000
    s_add_u32 s24, s26, 0x500000
    s_addc_u32 s25, s27, 0
    s_mov_b32 s26, 0x102000
    s_mov_b32 s27, 0x20000
    s_cmp_gt_u32 s99, 4
    s_cselect_b32 s22, 16, 0
    s_mov_b32 s40, s36
    s_mov_b32 s41, s37
    s_mov_b32 s42, 0
    s_mov_b32 s43, 0x20000
    s_mov_b32 s44, s36
    s_mov_b32 s45, s37
    s_mov_b32 s46, 0x300000
    s_mov_b32 s47, 0x20000
    s_lshl_b32 s80, s61, 17
    s_add_u32 s80, s80, 0x200000
    s_lshr_b32 s68, s64, 1
    s_and_b32 s100, s64, 1
    s_lshl_b32 s84, s61, 17
    s_lshl_b32 s101, s68, 10
    s_add_u32 s84, s84, s101
    s_lshl_b32 s101, s100, 7
    s_add_u32 s84, s84, s101
    s_lshl_b32 s101, s60, 5
    s_add_u32 s84, s84, s101
    s_lshl_b32 s101, s63, 8
    s_add_u32 s84, s84, s101
    s_add_u32 s84, s84, 0x10000
    s_lshl_b32 s85, s61, 17
    s_lshl_b32 s101, s63, 12
    s_add_u32 s85, s85, s101
    s_lshl_b32 s101, s60, 10
    s_nop 0
    s_add_u32 s85, s85, s101
    s_add_u32 s85, s85, 0x10000
    s_lshl_b32 s71, s61, 17
    s_lshl_b32 s101, s63, 10
    s_add_u32 s71, s71, s101
    s_lshr_b32 s70, s65, 9
    s_add_u32 s70, s70, s71
    s_mov_b32 s69, 0
    s_mov_b32 s94, 0
    s_mov_b32 s95, -2
    s_mov_b32 s6, 0x3f80
    s_mov_b32 s7, 0x3f800000
    s_and_b32 s100, s64, 3
    s_cmp_eq_u32 s100, 3
    s_cselect_b32 s15, 0, 1
    s_cmp_eq_u32 s63, 3
    s_cselect_b32 s100, 0, 2
    s_or_b32 s15, s15, s100
    s_bitcmp1_b32 s61, 0
    s_cselect_b32 s15, s15, 3
    s_lshr_b32 s68, s64, 2
    s_and_b32 s100, s64, 3
    s_lshl_b32 s72, s61, 17
    s_lshl_b32 s101, s60, 13
    s_add_u32 s72, s72, s101
    s_lshl_b32 s101, s68, 12
    s_add_u32 s72, s72, s101
    s_lshl_b32 s101, s63, 10
    s_add_u32 s72, s72, s101
    s_lshl_b32 s101, s100, 8
    s_add_u32 s72, s72, s101
    s_add_u32 s72, s72, 0x1000
    s_lshl_b32 s78, s61, 17
    s_lshl_b32 s101, s100, 12
    s_add_u32 s78, s78, s101
    s_lshl_b32 s101, s68, 7
    s_add_u32 s78, s78, s101
    s_lshl_b32 s101, s60, 5
    s_add_u32 s78, s78, s101
    s_lshl_b32 s101, s63, 8
    s_add_u32 s78, s78, s101
    s_add_u32 s78, s78, 0x9000
    s_lshl_b32 s73, s61, 17
    s_lshl_b32 s101, s63, 13
    s_add_u32 s73, s73, s101
    s_lshl_b32 s101, s60, 11
    s_add_u32 s73, s73, s101
    s_add_u32 s73, s73, 0x1000
    s_lshl_b32 s79, s61, 17
    s_lshl_b32 s101, s63, 12
    s_add_u32 s79, s79, s101
    s_lshl_b32 s101, s60, 10
    s_add_u32 s79, s79, s101
    s_add_u32 s79, s79, 0x9000
    s_lshl_b32 s74, s65, 3
    s_lshl_b32 s101, s61, 9
    s_add_u32 s74, s74, s101
    s_lshl_b32 s101, s63, 7
    s_add_u32 s74, s74, s101
    s_lshl_b32 s75, s62, 15
    s_lshr_b32 s68, s62, 1
    s_and_b32 s100, s62, 1
    s_lshl_b32 s76, s61, 17
    s_lshl_b32 s101, s68, 8
    s_add_u32 s76, s76, s101
    s_lshl_b32 s101, s100, 5
    s_add_u32 s76, s76, s101
    s_add_u32 s76, s76, 0xd000
    s_lshl_b32 s77, s61, 17
    s_lshl_b32 s101, s63, 10
    s_add_u32 s77, s77, s101
    s_add_u32 s77, s77, 0xd000
    s_lshl_b32 s83, s61, 17
    s_add_u32 s83, s83, 0xe000
    s_mov_b32 s88, 0xff00ff00
    s_mov_b32 s89, 0xff00ff00
    v_bfe_u32 v2, v0, 2, 1
    v_lshlrev_b32 v2, 12, v2
    v_lshrrev_b32 v7, 4, v0
    v_lshl_add_u32 v2, v7, 10, v2
    v_bfe_u32 v7, v0, 3, 1
    v_lshl_add_u32 v2, v7, 8, v2
    v_bfe_u32 v7, v0, 4, 1
    v_lshl_add_u32 v2, v7, 7, v2
    v_bfe_u32 v7, v0, 2, 1
    v_lshl_add_u32 v2, v7, 6, v2
    v_bfe_u32 v7, v0, 3, 1
    v_lshl_add_u32 v2, v7, 5, v2
    v_and_b32 v7, 3, v0
    v_lshl_add_u32 v2, v7, 3, v2
    v_add_u32 v2, s66, v2
    s_getpc_b64 s[98:99]
L_pc0:
    s_lshl_b32 s100, s62, 9
    s_lshl_b32 s101, s60, 7
    s_add_u32 s100, s100, s101
    s_min_u32 s100, s100, L_codeend-L_pc0-4
    v_mov_b32_e64 v121, s100
    global_load_dword v121, v121, s[98:99]
    v_mov_b32 v8, -1
    v_mov_b32 v9, -1
    v_mov_b32 v10, -1
    v_mov_b32 v11, -1
    v_lshlrev_b32_e64 v12, 2, v0
    s_or_b32 s14, s62, s60
    s_cmp_eq_u32 s14, 0
    s_cbranch_scc0 L_nolead0
    s_lshl_b32 s100, s61, 17
    buffer_store_dword v8, v12, s[36:39], s100 offen sc1
L_nolead0:
    s_mov_b32 s56, s4
    s_mov_b32 s57, s5
    s_mov_b32 s58, 4096
    s_mov_b32 s59, 0x20000
    v_lshrrev_b32 v6, 4, v0
    v_lshlrev_b32 v6, 6, v6
    v_bfe_u32 v7, v0, 2, 2
    v_lshl_add_u32 v6, v7, 10, v6
    v_and_b32 v7, 3, v0
    v_lshl_add_u32 v6, v7, 4, v6
    v_lshrrev_b32 v5, 5, v0
    v_lshlrev_b32_e64 v5, 10, v5
    v_bfe_u32 v7, v0, 4, 1
    v_lshl_add_u32 v5, v7, 11, v5
    v_and_b32 v7, 15, v0
    v_lshl_add_u32 v5, v7, 1, v5
    s_lshl_b32 s100, s63, 8
    s_lshl_b32 s101, s63, 10
    s_lshl_b32 s68, s62, 5
    buffer_load_dwordx4 v[56:59], v6, s[56:59], s100 offen
    buffer_load_dwordx4 v[60:63], v1, s[56:59], s101 offen
    buffer_load_ushort v3, v5, s[56:59], s68 offen
    s_add_u32 s67, s67, 0x20000
    s_and_b32 s67, s67, 0x1e0000
    s_or_b32 s68, s67, s65
    s_add_u32 m0, s66, 8192
    s_waitcnt vmcnt(9)
    buffer_load_dwordx4 v240, s[28:31], s68 offen offset:0 nt lds
    s_waitcnt vmcnt(9)
    buffer_load_dwordx4 v241, s[28:31], s68 offen offset:1024 nt lds
    s_waitcnt vmcnt(9)
    buffer_load_dwordx4 v242, s[28:31], s68 offen offset:2048 nt lds
    s_waitcnt vmcnt(9)
    buffer_load_dwordx4 v243, s[28:31], s68 offen offset:3072 nt lds
    v_lshrrev_b32 v52, 3, v0
    v_mul_u32_u24 v52, 8192, v52
    v_and_b32_e64 v53, 7, v0
    v_lshl_add_u32 v52, v53, 4, v52
    v_and_b32 v53, 32, v0
    v_xor_b32_e64 v52, v52, v53
    v_xor_b32_e64 v53, 64, v52
    s_mov_b32 s96, s10
    s_mov_b32 s97, s11
    s_mov_b32 s98, 0x400000
    s_mov_b32 s99, 0x20000
    s_lshl_b32 s86, s63, 20
    s_lshl_b32 s101, s60, 18
    s_add_u32 s86, s86, s101
    s_lshl_b32 s101, s61, 10
    s_add_u32 s86, s86, s101
    s_lshl_b32 s101, s64, 7
    s_add_u32 s86, s86, s101
    s_lshl_b32 s87, s60, 12
    s_add_u32 s87, s87, 0x18000
    s_add_u32 s68, s86, 0x0
    s_add_u32 m0, s87, 0x0
    s_waitcnt vmcnt(9)
    buffer_load_dwordx4 v52, s[96:99], s68 offen nt lds
    s_add_u32 s68, s86, 0x10000
    s_add_u32 m0, s87, 0x400
    s_waitcnt vmcnt(9)
    buffer_load_dwordx4 v53, s[96:99], s68 offen nt lds
    s_waitcnt vmcnt(14)
    ds_read_b128 a[0:3], v244 offset:0
    ds_read_b128 a[4:7], v245 offset:0
    ds_read_b128 a[8:11], v246 offset:0
    ds_read_b128 a[12:15], v247 offset:0
    s_cmp_eq_u32 s14, 0
    s_cbranch_scc0 L_nolead1
    s_waitcnt vmcnt(9)
    v_mov_b32 v55, 1
    v_lshlrev_b32 v54, 8, v0
    s_lshl_b32 s100, s61, 2
    buffer_store_dword v55, v54, s[52:55], s100 offen offset:0 sc1
L_nolead1:
    s_add_u32 s67, s67, 0x20000
    s_and_b32 s67, s67, 0x1e0000
    s_or_b32 s68, s67, s65
    s_add_u32 m0, s66, 12288
    s_waitcnt vmcnt(5)
    buffer_load_dwordx4 v240, s[28:31], s68 offen offset:0 nt lds
    s_nop 0
    s_waitcnt vmcnt(5)
    buffer_load_dwordx4 v241, s[28:31], s68 offen offset:1024 nt lds
    s_waitcnt vmcnt(5)
    buffer_load_dwordx4 v242, s[28:31], s68 offen offset:2048 nt lds
    s_waitcnt vmcnt(5)
    buffer_load_dwordx4 v243, s[28:31], s68 offen offset:3072 nt lds
    s_add_u32 s68, s86, 0x20000
    s_add_u32 m0, s87, 0x800
    s_waitcnt vmcnt(5)
    s_nop 0
    buffer_load_dwordx4 v52, s[96:99], s68 offen nt lds
    s_add_u32 s68, s86, 0x30000
    s_add_u32 m0, s87, 0xc00
    s_waitcnt vmcnt(5)
    buffer_load_dwordx4 v53, s[96:99], s68 offen nt lds
    s_waitcnt vmcnt(16)
    ds_read_b128 a[16:19], v244 offset:4096
    ds_read_b128 a[20:23], v245 offset:4096
    ds_read_b128 a[24:27], v246 offset:4096
    ds_read_b128 a[28:31], v247 offset:4096
    s_add_u32 s67, s67, 0x20000
    s_and_b32 s67, s67, 0x1e0000
    s_or_b32 s68, s67, s65
    s_add_u32 m0, s66, 16384
    s_waitcnt vmcnt(5)
    buffer_load_dwordx4 v240, s[28:31], s68 offen offset:0 nt lds
    s_waitcnt vmcnt(5)
    buffer_load_dwordx4 v241, s[28:31], s68 offen offset:1024 nt lds
    s_waitcnt vmcnt(5)
    buffer_load_dwordx4 v242, s[28:31], s68 offen offset:2048 nt lds
    s_waitcnt vmcnt(5)
    buffer_load_dwordx4 v243, s[28:31], s68 offen offset:3072 nt lds
    s_lshl_b32 s100, s62, 15
    s_lshl_b32 s101, s61, 11
    s_add_u32 s100, s100, s101
    s_lshl_b32 s101, s60, 9
    s_add_u32 s100, s100, s101
    v_add_u32 v12, s100, v1
    s_lshl_b32 s100, s2, 7
    s_add_u32 s100, s100, 0xffe00
    v_add_u32 v13, s100, v1
    v_cmp_gt_u32 vcc, 32, v0
    s_nop 1
    v_cndmask_b32 v12, v13, v12, vcc
    s_cmp_eq_u32 s60, 3
    s_cselect_b32 s100, 40, 32
    v_cmp_gt_u32 vcc, s100, v0
    v_mov_b32 v13, 0x7fff0000
    s_nop 0
    v_cndmask_b32_e64 v12, v13, v12, vcc
    buffer_store_dwordx4 v[8:11], v12, s[24:27], 0 offen sc1
    v_mov_b32 v70, 0x26200
    v_mov_b32 v71, 3
    ds_write_b32 v70, v71
    v_lshlrev_b32 v77, 24, v0
    s_lshl_b32 s91, s62, 0
    s_mul_i32 s101, s61, 3
    s_add_u32 s91, s91, s101
    s_and_b32 s91, s91, 31
    s_lshl_b32 s91, s91, 7
    s_add_u32 s91, s91, 0x100000
    s_waitcnt vmcnt(13)
    ds_read_b128 a[32:35], v244 offset:8192
    ds_read_b128 a[36:39], v245 offset:8192
    ds_read_b128 a[40:43], v246 offset:8192
    ds_read_b128 a[44:47], v247 offset:8192
    s_lshl_b32 s100, s61, 2
    v_mov_b32 v122, s100
    buffer_load_dword v122, v122, s[52:55], 0 offen offset:0 sc1
    s_add_u32 s67, s67, 0x20000
    s_and_b32 s67, s67, 0x1e0000
    s_or_b32 s68, s67, s65
    s_add_u32 m0, s66, 20480
    s_waitcnt vmcnt(9)
    buffer_load_dwordx4 v240, s[28:31], s68 offen offset:0 nt lds
    s_waitcnt vmcnt(9)
    buffer_load_dwordx4 v241, s[28:31], s68 offen offset:1024 nt lds
    s_waitcnt vmcnt(9)
    buffer_load_dwordx4 v242, s[28:31], s68 offen offset:2048 nt lds
    s_waitcnt vmcnt(9)
    buffer_load_dwordx4 v243, s[28:31], s68 offen offset:3072 nt lds
    s_waitcnt vmcnt(12)
    ds_read_b128 a[48:51], v244 offset:12288
    ds_read_b128 a[52:55], v245 offset:12288
    ds_read_b128 a[56:59], v246 offset:12288
    ds_read_b128 a[60:63], v247 offset:12288
    s_add_u32 s67, s67, 0x20000
    s_and_b32 s67, s67, 0x1e0000
    s_or_b32 s68, s67, s65
    s_add_u32 m0, s66, 0
    s_waitcnt lgkmcnt(1)
    s_waitcnt vmcnt(9)
    buffer_load_dwordx4 v240, s[28:31], s68 offen offset:0 nt lds
    s_waitcnt vmcnt(9)
    buffer_load_dwordx4 v241, s[28:31], s68 offen offset:1024 nt lds
    s_waitcnt vmcnt(9)
    buffer_load_dwordx4 v242, s[28:31], s68 offen offset:2048 nt lds
    s_waitcnt vmcnt(9)
    buffer_load_dwordx4 v243, s[28:31], s68 offen offset:3072 nt lds
    v_lshrrev_b32 v52, 3, v0
    v_mul_u32_u24 v52, 3584, v52
    v_and_b32_e64 v53, 7, v0
    v_lshl_add_u32 v52, v53, 4, v52
    v_and_b32 v53, 32, v0
    v_xor_b32_e64 v52, v52, v53
    v_xor_b32_e64 v53, 64, v52
    s_lshr_b32 s100, s61, 1
    s_mul_i32 s100, s100, 7
    s_and_b32 s68, s61, 1
    s_lshl_b32 s68, s68, 2
    s_add_u32 s100, s100, s68
    s_and_b32 s68, s64, 3
    s_add_u32 s100, s100, s68
    s_mul_i32 s86, s63, 458752
    s_mul_i32 s101, s60, 114688
    s_add_u32 s86, s86, s101
    s_lshl_b32 s101, s100, 7
    s_add_u32 s86, s86, s101
    s_lshl_b32 s87, s60, 12
    s_add_u32 s87, s87, 0x20000
    s_bitcmp1_b32 s15, 0
    s_cselect_b32 s100, 0x1c0000, 0
    s_mov_b32 s96, s16
    s_mov_b32 s97, s17
    s_mov_b32 s98, s100
    s_mov_b32 s99, 0x20000
    s_cmp_ge_u32 s64, 4
    s_cselect_b32 s96, s18, s16
    s_cselect_b32 s97, s19, s17
    s_add_u32 s68, s86, 0x0
    s_add_u32 m0, s87, 0x0
    s_waitcnt vmcnt(7)
    buffer_load_dwordx4 v52, s[96:99], s68 offen nt lds
    s_add_u32 s68, s86, 0x7000
    s_add_u32 m0, s87, 0x400
    s_waitcnt vmcnt(7)
    buffer_load_dwordx4 v53, s[96:99], s68 offen nt lds
    s_waitcnt vmcnt(12)
    ds_read_b128 a[64:67], v244 offset:16384
    ds_read_b128 a[68:71], v245 offset:16384
    ds_read_b128 a[72:75], v246 offset:16384
    ds_read_b128 a[76:79], v247 offset:16384
    s_waitcnt vmcnt(10)
    s_branch L_f0_c
L_f0_s:
    s_sleep 8
    s_lshl_b32 s100, s61, 2
    v_mov_b32 v122, s100
    buffer_load_dword v122, v122, s[52:55], 0 offen offset:0 sc1
    s_add_u32 s94, s94, 1
    s_cmp_lt_u32 s94, 0x40000
    s_waitcnt vmcnt(0)
    s_cbranch_scc0 L_f0_d
L_f0_c:
    v_cmp_eq_u32 vcc, 0, v122
    s_cbranch_vccnz L_f0_s
L_f0_d:
    s_barrier
    s_getreg_b32 s68, hwreg(HW_REG_XCC_ID, 0, 4)
    s_or_b32 s68, s68, s22
    v_mov_b32 v14, s68
    v_add_u32 v15, s60, v0
    v_lshlrev_b32_e64 v15, 24, v15
    s_lshl_b32 s100, s61, 17
    s_lshl_b32 s101, s62, 2
    s_add_u32 s100, s100, s101
    buffer_store_dword v14, v15, s[40:43], s100 offen
    s_cmp_eq_u32 s42, 0
    s_cbranch_scc1 L_slow1
L_slow1_b:
    v_lshlrev_b32_e64 v3, 16, v3
    s_mov_b32 s100, 0x3f803f80
    v_dot2_f32_bf16 v8, v60, s100, 0
    v_dot2_f32_bf16 v9, v60, v60, 0
    v_dot2_f32_bf16 v8, v61, s100, v8
    v_dot2_f32_bf16 v9, v61, v61, v9
    v_dot2_f32_bf16 v8, v62, s100, v8
    v_dot2_f32_bf16 v9, v62, v62, v9
    v_dot2_f32_bf16 v8, v63, s100, v8
    v_dot2_f32_bf16 v9, v63, v63, v9
    s_nop 2
    v_permlane32_swap_b32 v8, v9
    v_add_f32_e64 v8, v8, v9
    s_nop 1
    v_add_f32_dpp v8, v8, v8 row_ror:1 row_mask:0xf bank_mask:0xf
    s_nop 1
    v_add_f32_dpp v8, v8, v8 row_ror:2 row_mask:0xf bank_mask:0xf
    s_nop 1
    v_add_f32_dpp v8, v8, v8 row_ror:4 row_mask:0xf bank_mask:0xf
    s_nop 1
    v_add_f32_dpp v8, v8, v8 row_ror:8 row_mask:0xf bank_mask:0xf
    s_nop 1
    v_add_f32_dpp v8, v8, v8 row_bcast:15 row_mask:0xa bank_mask:0xf
    s_nop 0
    v_readlane_b32 s81, v8, 31
    v_mul_f32 v8, 0x3b000000, v8
    s_nop 0
    v_mov_b32 v9, s81
    v_mul_f32 v9, 0x3b000000, v9
    v_fma_f32 v8, -v9, v9, v8
    v_max_f32_e64 v8, 0, v8
    v_add_f32 v8, 0x3727c5ac, v8
    v_rsq_f32 v8, v8
    s_nop 0
    v_mul_f32 v8, 0x3e0293ee, v8
    s_nop 0
    v_readlane_b32 s82, v8, 63
    s_add_u32 s67, s67, 0x20000
    s_and_b32 s67, s67, 0x1e0000
    s_or_b32 s68, s67, s65
    s_add_u32 m0, s66, 4096
    s_waitcnt lgkmcnt(1)
    s_waitcnt vmcnt(6)
    buffer_load_dwordx4 v240, s[28:31], s68 offen offset:0 nt lds
    s_waitcnt vmcnt(6)
    buffer_load_dwordx4 v241, s[28:31], s68 offen offset:1024 nt lds
    s_waitcnt vmcnt(6)
    buffer_load_dwordx4 v242, s[28:31], s68 offen offset:2048 nt lds
    s_waitcnt vmcnt(6)
    buffer_load_dwordx4 v243, s[28:31], s68 offen offset:3072 nt lds
    s_add_u32 s68, s86, 0xe000
    s_add_u32 m0, s87, 0x800
    s_waitcnt vmcnt(6)
    buffer_load_dwordx4 v52, s[96:99], s68 offen nt lds
    s_add_u32 s68, s86, 0x15000
    s_add_u32 m0, s87, 0xc00
    s_waitcnt vmcnt(6)
    buffer_load_dwordx4 v53, s[96:99], s68 offen nt lds
    s_waitcnt vmcnt(13)
    ds_read_b128 a[80:83], v244 offset:20480
    ds_read_b128 a[84:87], v245 offset:20480
    ds_read_b128 a[88:91], v246 offset:20480
    ds_read_b128 a[92:95], v247 offset:20480
    s_add_u32 s67, s67, 0x20000
    s_and_b32 s67, s67, 0x1e0000
    s_or_b32 s68, s67, s65
    s_add_u32 m0, s66, 8192
    s_waitcnt lgkmcnt(1)
    s_waitcnt vmcnt(5)
    buffer_load_dwordx4 v240, s[28:31], s68 offen offset:0 nt lds
    s_waitcnt vmcnt(5)
    buffer_load_dwordx4 v241, s[28:31], s68 offen offset:1024 nt lds
    s_waitcnt vmcnt(5)
    buffer_load_dwordx4 v242, s[28:31], s68 offen offset:2048 nt lds
    s_waitcnt vmcnt(5)
    buffer_load_dwordx4 v243, s[28:31], s68 offen offset:3072 nt lds
    s_waitcnt vmcnt(13)
    ds_read_b128 a[96:99], v244 offset:0
    ds_read_b128 a[100:103], v245 offset:0
    ds_read_b128 a[104:107], v246 offset:0
    ds_read_b128 a[108:111], v247 offset:0
    s_add_u32 s67, s67, 0x20000
    s_and_b32 s67, s67, 0x1e0000
    s_or_b32 s68, s67, s65
    s_add_u32 m0, s66, 12288
    s_waitcnt lgkmcnt(1)
    s_waitcnt vmcnt(5)
    buffer_load_dwordx4 v240, s[28:31], s68 offen offset:0 nt lds
    s_waitcnt vmcnt(5)
    buffer_load_dwordx4 v241, s[28:31], s68 offen offset:1024 nt lds
    s_waitcnt vmcnt(5)
    buffer_load_dwordx4 v242, s[28:31], s68 offen offset:2048 nt lds
    s_waitcnt vmcnt(5)
    buffer_load_dwordx4 v243, s[28:31], s68 offen offset:3072 nt lds
    s_waitcnt vmcnt(10)
    ds_read_b128 a[112:115], v244 offset:4096
    ds_read_b128 a[116:119], v245 offset:4096
    ds_read_b128 a[120:123], v246 offset:4096
    ds_read_b128 a[124:127], v247 offset:4096
    v_and_b32_e64 v123, 31, v0
    v_lshlrev_b32 v123, 2, v123
    s_lshl_b32 s101, s61, 17
    buffer_load_dword v122, v123, s[36:39], s101 offen offset:0 sc1
    s_add_u32 s67, s67, 0x20000
    s_and_b32 s67, s67, 0x1e0000
    s_or_b32 s68, s67, s65
    s_add_u32 m0, s66, 16384
    s_waitcnt lgkmcnt(1)
    s_waitcnt vmcnt(6)
    buffer_load_dwordx4 v240, s[28:31], s68 offen offset:0 nt lds
    s_waitcnt vmcnt(6)
    buffer_load_dwordx4 v241, s[28:31], s68 offen offset:1024 nt lds
    s_waitcnt vmcnt(6)
    buffer_load_dwordx4 v242, s[28:31], s68 offen offset:2048 nt lds
    s_waitcnt vmcnt(6)
    buffer_load_dwordx4 v243, s[28:31], s68 offen offset:3072 nt lds
    s_waitcnt vmcnt(9)
    ds_read_b128 a[128:131], v244 offset:8192
    ds_read_b128 a[132:135], v245 offset:8192
    ds_read_b128 a[136:139], v246 offset:8192
    ds_read_b128 a[140:143], v247 offset:8192
    s_add_u32 s67, s67, 0x20000
    s_and_b32 s67, s67, 0x1e0000
    s_or_b32 s68, s67, s65
    s_add_u32 m0, s66, 20480
    s_waitcnt lgkmcnt(1)
    s_waitcnt vmcnt(6)
    buffer_load_dwordx4 v240, s[28:31], s68 offen offset:0 nt lds
    s_waitcnt vmcnt(6)
    buffer_load_dwordx4 v241, s[28:31], s68 offen offset:1024 nt lds
    s_waitcnt vmcnt(5)
    buffer_load_dwordx4 v242, s[28:31], s68 offen offset:2048 nt lds
    s_waitcnt vmcnt(5)
    buffer_load_dwordx4 v243, s[28:31], s68 offen offset:3072 nt lds
    s_waitcnt vmcnt(9)
    ds_read_b128 a[144:147], v244 offset:12288
    ds_read_b128 a[148:151], v245 offset:12288
    ds_read_b128 a[152:155], v246 offset:12288
    ds_read_b128 a[156:159], v247 offset:12288
    s_branch L_xcc_c
L_xcc_r:
    s_lshl_b32 s101, s61, 17
    buffer_load_dword v122, v123, s[36:39], s101 offen offset:0 sc1
    s_add_u32 s94, s94, 1
    s_cmp_lt_u32 s94, 0x40000
    s_cselect_b32 s95, -2, -1
    s_waitcnt vmcnt(0)
L_xcc_c:
    s_waitcnt vmcnt(8)
    v_cmp_lt_u32 vcc, s95, v122
    s_cbranch_vccnz L_xcc_r
    s_barrier
    v_bfe_u32 v5, v0, 4, 1
    v_lshlrev_b32 v5, 5, v5
    v_bfe_u32 v7, v0, 3, 1
    v_lshl_add_u32 v5, v7, 6, v5
    s_lshl_b32 s100, s60, 5
    v_xor_b32 v5, s100, v5
    v_add_u32 v5, 0x18000, v5
    v_bfe_u32 v7, v0, 5, 1
    v_lshl_add_u32 v5, v7, 12, v5
    v_bfe_u32 v7, v0, 3, 1
    v_lshl_add_u32 v5, v7, 10, v5
    v_bfe_u32 v7, v0, 4, 1
    v_lshl_add_u32 v5, v7, 9, v5
    v_bfe_u32 v7, v0, 2, 1
    v_lshl_add_u32 v5, v7, 7, v5
    v_bfe_u32 v7, v0, 0, 2
    v_lshl_add_u32 v5, v7, 3, v5
    ds_read_b64_tr_b16 v[32:33], v5 offset:0
    ds_read_b64_tr_b16 v[34:35], v5 offset:256
    ds_read_b64_tr_b16 v[36:37], v5 offset:8192
    ds_read_b64_tr_b16 v[38:39], v5 offset:8448
    ds_read_b64_tr_b16 v[40:41], v5 offset:2048
    ds_read_b64_tr_b16 v[42:43], v5 offset:2304
    ds_read_b64_tr_b16 v[44:45], v5 offset:10240
    ds_read_b64_tr_b16 v[46:47], v5 offset:10496
    v_cmp_lt_u32 vcc, 15, v122
    v_and_b32 v122, 15, v122
    s_and_b32 s100, vcc_lo, 0x55555555
    s_and_b32 s101, vcc_lo, 0xaaaaaaaa
    s_bcnt1_i32_b32 s100, s100
    s_bcnt1_i32_b32 s101, s101
    s_getreg_b32 s22, hwreg(HW_REG_XCC_ID, 0, 4)
    s_sub_u32 s68, s100, s101
    s_sub_u32 s101, s101, s100
    s_bitcmp1_b32 s22, 2
    s_cselect_b32 s101, s101, s68
    s_add_u32 s101, s101, 64
    s_cmp_eq_u32 s14, 0
    s_cbranch_scc0 L_nolead2
    v_mov_b32 v55, s101
    v_lshlrev_b32 v54, 8, v0
    s_lshl_b32 s100, s61, 2
    buffer_store_dword v55, v54, s[52:55], s100 offen offset:32 sc1
L_nolead2:
    v_cmp_ne_u32 vcc, s22, v122
    s_nop 0
    s_cmp_eq_u64 vcc, 0
    s_cselect_b32 s42, 0x300000, 0
    s_cselect_b32 s46, 0, 0x300000
    v_lshrrev_b32 v6, 4, v0
    v_lshlrev_b32 v6, 12, v6
    v_and_b32 v7, 15, v0
    v_lshl_add_u32 v6, v7, 1, v6
    v_and_b32 v7, 1, v0
    v_cmp_eq_u32 vcc, 0, v7
    v_mov_b32 v7, 0x7fff0000
    s_nop 0
    v_cndmask_b32_e64 v6, v7, v6, vcc
    s_lshr_b32 s68, s64, 1
    s_and_b32 s3, s64, 1
    v_mov_b32 v12, 0x3f803f80
    v_mov_b32 v13, 0x3f803f80
    v_mov_b32 v14, 0x3f803f80
    v_mov_b32 v15, 0x3f803f80
    v_and_b32 v10, 1, v0
    v_lshlrev_b32 v10, 10, v10
    v_bfe_u32 v11, v0, 1, 3
    v_lshl_add_u32 v10, v11, 4, v10
    v_cmp_gt_u32 vcc, 16, v0
    v_mov_b32 v11, 0x7fff0000
    s_nop 0
    v_cndmask_b32_e64 v10, v11, v10, vcc
    s_lshl_b32 s100, s80, 0
    s_lshl_b32 s101, s63, 2
    s_add_u32 s100, s100, s101
    s_lshl_b32 s101, s60, 7
    s_add_u32 s100, s100, s101
    s_lshl_b32 s101, s68, 11
    s_add_u32 s100, s100, s101
    s_lshl_b32 s101, s3, 9
    s_add_u32 s100, s100, s101
    s_add_u32 s100, s100, 0x11000
    s_waitcnt lgkmcnt(0)
    v_mfma_f32_16x16x32_bf16 v[16:19], v[12:15], v[32:35], 0
    v_mfma_f32_16x16x32_bf16 v[16:19], v[12:15], v[36:39], v[16:19]
    v_mfma_f32_16x16x32_bf16 v[16:19], v[12:15], v[40:43], v[16:19]
    v_mfma_f32_16x16x32_bf16 v[16:19], v[12:15], v[44:47], v[16:19]
    s_nop 7
    buffer_store_dword v16, v10, s[40:43], s100 offen
    s_cmp_eq_u32 s42, 0
    s_cbranch_scc1 L_slow2
L_slow2_b:
    v_and_b32 v8, 1, v0
    v_mul_u32_u24 v8, 0xaaaa, v8
    v_add_u32 v8, 0x4444, v8
    v_mov_b64_e64 v[80:81], 0
    v_mov_b64 v[90:91], 0
    s_nop 0
    v_smfmac_f32_16x16x64_bf16 v[80:83], v[56:59], v[32:39], v8
    v_smfmac_f32_16x16x64_bf16 v[88:91], v[56:59], v[40:47], v8
    v_mov_b32_e64 v20, -1
    v_mov_b32 v21, -1
    v_mov_b32_e64 v22, -1
    v_mov_b32_e64 v23, -1
    s_nop 2
    v_add_f32_e64 v80, v80, v81
    v_add_f32 v90, v90, v91
    v_add_f32_e64 v80, v80, v90
    s_nop 1
    v_mov_b32_dpp v9, v80 quad_perm:[1,1,3,3] row_mask:0xf bank_mask:0xf
    v_cvt_pk_bf16_f32 v9, v80, v9
    buffer_store_dword v9, v6, s[40:43], s84 offen
    s_cmp_eq_u32 s42, 0
    s_cbranch_scc1 L_slow3
L_slow3_b:
    s_lshl_b32 s100, s61, 17
    s_mul_i32 s101, s62, 1152
    s_add_u32 s100, s100, s101
    s_mul_i32 s101, s60, 288
    s_add_u32 s100, s100, s101
    s_add_u32 s100, s100, 0x100000
    v_mov_b32 v24, v1
    v_cmp_gt_u32_e64 vcc, 18, v0
    v_mov_b32 v7, 0x7fff0000
    s_nop 0
    v_cndmask_b32 v24, v7, v24, vcc
    buffer_store_dwordx4 v[20:23], v24, s[40:43], s100 offen
    s_cmp_eq_u32 s42, 0
    s_cbranch_scc1 L_slow4
L_slow4_b:
    s_add_u32 s67, s67, 0x20000
    s_and_b32 s67, s67, 0x1e0000
    s_or_b32 s68, s67, s65
    s_add_u32 m0, s66, 0
    s_waitcnt lgkmcnt(1)
    s_waitcnt vmcnt(8)
    buffer_load_dwordx4 v240, s[28:31], s68 offen offset:0 nt lds
    s_waitcnt vmcnt(8)
    buffer_load_dwordx4 v241, s[28:31], s68 offen offset:1024 nt lds
    s_waitcnt vmcnt(8)
    buffer_load_dwordx4 v242, s[28:31], s68 offen offset:2048 nt lds
    s_waitcnt vmcnt(8)
    buffer_load_dwordx4 v243, s[28:31], s68 offen offset:3072 nt lds
    s_waitcnt vmcnt(11)
    ds_read_b128 a[160:163], v244 offset:16384
    ds_read_b128 a[164:167], v245 offset:16384
    ds_read_b128 a[168:171], v246 offset:16384
    ds_read_b128 a[172:175], v247 offset:16384
    s_add_u32 s67, s67, 0x20000
    s_and_b32 s67, s67, 0x1e0000
    s_or_b32 s68, s67, s65
    s_add_u32 m0, s66, 4096
    s_waitcnt lgkmcnt(1)
    s_waitcnt vmcnt(8)
    buffer_load_dwordx4 v240, s[28:31], s68 offen offset:0 nt lds
    s_waitcnt vmcnt(8)
    buffer_load_dwordx4 v241, s[28:31], s68 offen offset:1024 nt lds
    s_waitcnt vmcnt(5)
    buffer_load_dwordx4 v242, s[28:31], s68 offen offset:2048 nt lds
    s_waitcnt vmcnt(5)
    buffer_load_dwordx4 v243, s[28:31], s68 offen offset:3072 nt lds
    s_waitcnt vmcnt(11)
    ds_read_b128 a[176:179], v244 offset:20480
    ds_read_b128 a[180:183], v245 offset:20480
    s_nop 0
    ds_read_b128 a[184:187], v246 offset:20480
    ds_read_b128 a[188:191], v247 offset:20480
    s_waitcnt vmcnt(8)
    s_barrier
    v_mov_b32 v14, 1
    v_add_u32 v15, s60, v0
    v_lshlrev_b32 v15, 24, v15
    s_lshl_b32 s100, s61, 17
    s_lshl_b32 s101, s62, 2
    s_add_u32 s100, s100, s101
    s_add_u32 s100, s100, 0x80
    buffer_store_dword v14, v15, s[40:43], s100 offen
    s_cmp_eq_u32 s42, 0
    s_cbranch_scc1 L_slow5
L_slow5_b:
    v_bfe_u32 v5, v0, 4, 1
    v_lshlrev_b32 v5, 5, v5
    v_bfe_u32 v7, v0, 3, 1
    v_lshl_add_u32 v5, v7, 6, v5
    s_lshl_b32 s100, s60, 5
    v_xor_b32_e64 v5, s100, v5
    v_add_u32 v5, 0x18000, v5
    v_bfe_u32 v7, v0, 5, 1
    v_lshl_add_u32 v5, v7, 12, v5
    v_bfe_u32 v7, v0, 3, 1
    v_lshl_add_u32 v5, v7, 10, v5
    v_bfe_u32 v7, v0, 4, 1
    v_lshl_add_u32 v5, v7, 9, v5
    v_bfe_u32 v7, v0, 2, 1
    v_lshl_add_u32 v5, v7, 7, v5
    v_bfe_u32 v7, v0, 0, 2
    v_lshl_add_u32 v5, v7, 3, v5
    ds_read_b64_tr_b16 v[32:33], v5 offset:32768
    ds_read_b64_tr_b16 v[34:35], v5 offset:33024
    ds_read_b64_tr_b16 v[36:37], v5 offset:40960
    ds_read_b64_tr_b16 v[38:39], v5 offset:41216
    ds_read_b64_tr_b16 v[40:41], v5 offset:34816
    ds_read_b64_tr_b16 v[42:43], v5 offset:35072
    ds_read_b64_tr_b16 v[44:45], v5 offset:43008
    ds_read_b64_tr_b16 v[46:47], v5 offset:43264
    s_lshr_b32 s68, s64, 2
    s_and_b32 s3, s64, 3
    v_mov_b32 v16, 0x3f803f80
    v_mov_b32 v17, 0x3f803f80
    v_mov_b32 v18, 0x3f803f80
    v_mov_b32 v19, 0x3f803f80
    v_and_b32_e64 v10, 1, v0
    v_lshlrev_b32_e64 v10, 10, v10
    v_bfe_u32 v11, v0, 1, 3
    v_lshl_add_u32 v10, v11, 4, v10
    v_cmp_gt_u32 vcc, 16, v0
    v_mov_b32 v11, 0x7fff0000
    s_nop 0
    v_cndmask_b32_e64 v10, v11, v10, vcc
    s_lshl_b32 s100, s80, 0
    s_lshl_b32 s101, s63, 2
    s_add_u32 s100, s100, s101
    s_lshl_b32 s101, s60, 7
    s_add_u32 s100, s100, s101
    s_lshl_b32 s101, s3, 11
    s_add_u32 s100, s100, s101
    s_lshl_b32 s101, s68, 9
    s_add_u32 s100, s100, s101
    s_add_u32 s100, s100, 0xf000
    s_waitcnt lgkmcnt(0)
    v_mfma_f32_16x16x32_bf16 v[20:23], v[16:19], v[32:35], 0
    v_mfma_f32_16x16x32_bf16 v[20:23], v[16:19], v[36:39], v[20:23]
    v_mfma_f32_16x16x32_bf16 v[20:23], v[16:19], v[40:43], v[20:23]
    v_mfma_f32_16x16x32_bf16 v[20:23], v[16:19], v[44:47], v[20:23]
    s_nop 7
    buffer_store_dword v20, v10, s[40:43], s100 offen
    s_cmp_eq_u32 s42, 0
    s_cbranch_scc1 L_slow6
L_slow6_b:
    s_add_u32 s67, s67, 0x20000
    s_and_b32 s67, s67, 0x1e0000
    s_or_b32 s68, s67, s65
    s_add_u32 m0, s66, 8192
    s_waitcnt lgkmcnt(1)
    s_waitcnt vmcnt(7)
    buffer_load_dwordx4 v240, s[28:31], s68 offen offset:0 nt lds
    s_waitcnt vmcnt(7)
    buffer_load_dwordx4 v241, s[28:31], s68 offen offset:1024 nt lds
    s_waitcnt vmcnt(7)
    buffer_load_dwordx4 v242, s[28:31], s68 offen offset:2048 nt lds
    s_waitcnt vmcnt(7)
    buffer_load_dwordx4 v243, s[28:31], s68 offen offset:3072 nt lds
    s_waitcnt vmcnt(10)
    ds_read_b128 a[192:195], v244 offset:0
    ds_read_b128 a[196:199], v245 offset:0
    ds_read_b128 a[200:203], v246 offset:0
    ds_read_b128 a[204:207], v247 offset:0
    s_cmp_eq_u32 s60, 1
    s_cbranch_scc0 L_tka0
    v_mov_b32_e64 v71, 1
    buffer_atomic_add v71, v77, s[24:27], s91 offen sc0 sc1
    s_add_u32 s91, s91, 4096
L_tka0:
    s_add_u32 s67, s67, 0x20000
    s_and_b32 s67, s67, 0x1e0000
    s_or_b32 s68, s67, s65
    s_add_u32 m0, s66, 12288
    s_waitcnt lgkmcnt(1)
    s_nop 0
    s_waitcnt vmcnt(7)
    buffer_load_dwordx4 v240, s[28:31], s68 offen offset:0 nt lds
    s_waitcnt vmcnt(7)
    buffer_load_dwordx4 v241, s[28:31], s68 offen offset:1024 nt lds
    s_waitcnt vmcnt(5)
    buffer_load_dwordx4 v242, s[28:31], s68 offen offset:2048 nt lds
    s_waitcnt vmcnt(5)
    buffer_load_dwordx4 v243, s[28:31], s68 offen offset:3072 nt lds
    s_waitcnt vmcnt(10)
    ds_read_b128 a[208:211], v244 offset:4096
    ds_read_b128 a[212:215], v245 offset:4096
    ds_read_b128 a[216:219], v246 offset:4096
    ds_read_b128 a[220:223], v247 offset:4096
    v_lshrrev_b32 v5, 4, v0
    v_lshlrev_b32 v5, 8, v5
    v_and_b32_e64 v7, 15, v0
    v_lshl_add_u32 v5, v7, 4, v5
    v_and_b32 v7, 16, v0
    v_lshlrev_b32 v7, 1, v7
    v_xor_b32_e64 v5, v5, v7
    v_xor_b32 v6, 128, v5
    v_xor_b32_e64 v57, 32, v2
    v_xor_b32_e64 v58, 64, v2
    v_xor_b32 v59, 96, v2
    v_xor_b32 v60, 128, v2
    v_xor_b32 v61, 160, v2
    v_xor_b32 v62, 192, v2
    v_xor_b32 v63, 224, v2
    v_and_b32_e64 v56, 1, v0
    v_mul_u32_u24 v56, 0xaaaa, v56
    v_add_u32 v56, 0x4444, v56
    s_add_u32 s67, s67, 0x20000
    s_and_b32 s67, s67, 0x1e0000
    s_or_b32 s68, s67, s65
    s_add_u32 m0, s66, 16384
    s_waitcnt lgkmcnt(1)
    s_waitcnt vmcnt(5)
    buffer_load_dwordx4 v5, s[32:35], s68 offen offset:0 nt lds
    s_waitcnt vmcnt(5)
    buffer_load_dwordx4 v6, s[32:35], s68 offen offset:1024 nt lds
    s_waitcnt vmcnt(5)
    buffer_load_dwordx4 v5, s[32:35], s68 offen offset:2048 nt lds
    s_waitcnt vmcnt(5)
    buffer_load_dwordx4 v6, s[32:35], s68 offen offset:3072 nt lds
    v_xor_b32 v5, 64, v5
    v_xor_b32_e64 v6, 64, v6
    s_waitcnt vmcnt(8)
    ds_read_b128 a[224:227], v244 offset:8192
    ds_read_b128 a[228:231], v245 offset:8192
    ds_read_b128 a[232:235], v246 offset:8192
    ds_read_b128 a[236:239], v247 offset:8192
    v_and_b32 v123, 31, v0
    v_lshlrev_b32_e64 v123, 2, v123
    s_lshl_b32 s101, s61, 17
    buffer_load_dword v122, v123, s[36:39], s101 offen offset:128 sc1
    s_cmp_eq_u32 s60, 1
    s_cbranch_scc0 L_tkb0
    s_waitcnt vmcnt(9)
    v_readfirstlane_b32 s4, v71
    s_nop 0
    s_add_u32 s4, s4, 1
    v_mov_b32_e64 v71, s4
    ds_write_b32 v70, v71
L_tkb0:
    s_add_u32 s67, s67, 0x20000
    s_and_b32 s67, s67, 0x1e0000
    s_or_b32 s68, s67, s65
    s_add_u32 m0, s66, 20480
    s_waitcnt lgkmcnt(1)
    s_waitcnt vmcnt(6)
    buffer_load_dwordx4 v5, s[32:35], s68 offen offset:0 nt lds
    s_waitcnt vmcnt(6)
    buffer_load_dwordx4 v6, s[32:35], s68 offen offset:1024 nt lds
    s_waitcnt vmcnt(6)
    buffer_load_dwordx4 v5, s[32:35], s68 offen offset:2048 nt lds
    s_waitcnt vmcnt(6)
    buffer_load_dwordx4 v6, s[32:35], s68 offen offset:3072 nt lds
    v_xor_b32 v5, 64, v5
    v_xor_b32 v6, 64, v6
    ds_read_b32 v76, v70
    s_waitcnt lgkmcnt(0)
    v_readfirstlane_b32 s4, v76
    s_nop 0
    s_cmp_ge_u32 s4, 3
    s_cselect_b32 s90, 1, 0
    s_cmp_ge_u32 s4, 6
    s_addc_u32 s90, s90, 0
    s_waitcnt vmcnt(9)
    ds_read_b128 a[240:243], v244 offset:12288
    ds_read_b128 a[244:247], v245 offset:12288
    ds_read_b128 a[248:251], v246 offset:12288
    ds_read_b128 a[252:255], v247 offset:12288
    s_add_u32 s67, s67, 0x20000
    s_and_b32 s67, s67, 0x1e0000
    s_or_b32 s68, s67, s65
    s_add_u32 m0, s66, 0
    s_waitcnt lgkmcnt(1)
    s_waitcnt vmcnt(7)
    s_cmp_gt_u32 s90, 1
    s_cbranch_scc1 L_th_1
    s_waitcnt vmcnt(6)
    s_cmp_gt_u32 s90, 0
    s_cbranch_scc1 L_th_1
    s_waitcnt vmcnt(5)
L_th_1:
    buffer_load_dwordx4 v5, s[32:35], s68 offen offset:0 nt lds
    s_waitcnt vmcnt(7)
    s_cmp_gt_u32 s90, 1
    s_cbranch_scc1 L_th_2
    s_waitcnt vmcnt(6)
    s_cmp_gt_u32 s90, 0
    s_cbranch_scc1 L_th_2
    s_waitcnt vmcnt(4)
L_th_2:
    buffer_load_dwordx4 v6, s[32:35], s68 offen offset:1024 nt lds
    s_waitcnt vmcnt(7)
    s_cmp_gt_u32 s90, 1
    s_cbranch_scc1 L_th_3
    s_waitcnt vmcnt(5)
    s_cmp_gt_u32 s90, 0
    s_cbranch_scc1 L_th_3
    s_waitcnt vmcnt(4)
L_th_3:
    buffer_load_dwordx4 v5, s[32:35], s68 offen offset:2048 nt lds
    s_waitcnt vmcnt(6)
    s_cmp_gt_u32 s90, 1
    s_cbranch_scc1 L_th_4
    s_waitcnt vmcnt(5)
    s_cmp_gt_u32 s90, 0
    s_cbranch_scc1 L_th_4
    s_waitcnt vmcnt(4)
L_th_4:
    buffer_load_dwordx4 v6, s[32:35], s68 offen offset:3072 nt lds
    v_xor_b32 v5, 64, v5
    v_xor_b32 v6, 64, v6
    s_branch L_q1_c
L_q1_r:
    s_lshl_b32 s101, s61, 17
    buffer_load_dword v122, v123, s[36:39], s101 offen offset:128 sc1
    s_add_u32 s94, s94, 1
    s_cmp_lt_u32 s94, 0x40000
    s_cselect_b32 s95, -2, -1
    s_waitcnt vmcnt(0)
L_q1_c:
    s_waitcnt vmcnt(8)
    v_cmp_lt_u32 vcc, s95, v122
    s_cbranch_vccnz L_q1_r
    s_lshl_b32 s100, s80, 0
    s_lshl_b32 s101, s60, 11
    s_add_u32 s100, s100, s101
    s_add_u32 s100, s100, 0x11000
    buffer_load_dwordx4 v[28:31], v1, s[36:39], s100 offen offset:0 sc1
    buffer_load_dwordx4 v[32:35], v1, s[36:39], s100 offen offset:1024 sc1
    v_lshlrev_b32_e64 v7, 2, v0
    buffer_load_dword v24, v7, s[36:39], s85 offen offset:0 sc1
    buffer_load_dword v25, v7, s[36:39], s85 offen offset:256 sc1
    buffer_load_dword v26, v7, s[36:39], s85 offen offset:512 sc1
    buffer_load_dword v27, v7, s[36:39], s85 offen offset:768 sc1
    s_add_u32 s36, s36, 0x100000
    s_addc_u32 s37, s37, 0
    s_add_u32 s40, s40, 0x100000
    s_addc_u32 s41, s41, 0
    s_add_u32 s44, s44, 0x100000
    s_addc_u32 s45, s45, 0
    s_sub_u32 s80, s80, 0x100000
    s_add_u32 s67, s67, 0x20000
    s_and_b32 s67, s67, 0x1e0000
    s_or_b32 s68, s67, s65
    s_add_u32 m0, s66, 4096
    s_waitcnt lgkmcnt(1)
    s_waitcnt vmcnt(12)
    s_cmp_gt_u32 s90, 1
    s_cbranch_scc1 L_th_5
    s_waitcnt vmcnt(11)
    s_cmp_gt_u32 s90, 0
    s_cbranch_scc1 L_th_5
    s_waitcnt vmcnt(10)
L_th_5:
    buffer_load_dwordx4 v5, s[32:35], s68 offen offset:0 nt lds
    s_waitcnt vmcnt(12)
    s_cmp_gt_u32 s90, 1
    s_cbranch_scc1 L_th_6
    s_waitcnt vmcnt(11)
    s_cmp_gt_u32 s90, 0
    s_cbranch_scc1 L_th_6
    s_waitcnt vmcnt(10)
L_th_6:
    buffer_load_dwordx4 v6, s[32:35], s68 offen offset:1024 nt lds
    s_waitcnt vmcnt(12)
    s_cmp_gt_u32 s90, 1
    s_cbranch_scc1 L_th_7
    s_waitcnt vmcnt(11)
    s_cmp_gt_u32 s90, 0
    s_cbranch_scc1 L_th_7
    s_waitcnt vmcnt(10)
L_th_7:
    buffer_load_dwordx4 v5, s[32:35], s68 offen offset:2048 nt lds
    s_waitcnt vmcnt(12)
    s_cmp_gt_u32 s90, 1
    s_cbranch_scc1 L_th_8
    s_waitcnt vmcnt(11)
    s_cmp_gt_u32 s90, 0
    s_cbranch_scc1 L_th_8
    s_waitcnt vmcnt(10)
L_th_8:
    buffer_load_dwordx4 v6, s[32:35], s68 offen offset:3072 nt lds
    v_xor_b32 v5, 64, v5
    v_xor_b32 v6, 64, v6
    s_waitcnt vmcnt(14)
    ds_read_b64_tr_b16 v[128:129], v2 offset:16384
    ds_read_b64_tr_b16 v[130:131], v2 offset:16896
    ds_read_b64_tr_b16 v[136:137], v57 offset:16384
    ds_read_b64_tr_b16 v[138:139], v57 offset:16896
    ds_read_b64_tr_b16 v[144:145], v58 offset:16384
    ds_read_b64_tr_b16 v[146:147], v58 offset:16896
    ds_read_b64_tr_b16 v[152:153], v59 offset:16384
    ds_read_b64_tr_b16 v[154:155], v59 offset:16896
    ds_read_b64_tr_b16 v[160:161], v60 offset:16384
    ds_read_b64_tr_b16 v[162:163], v60 offset:16896
    ds_read_b64_tr_b16 v[168:169], v61 offset:16384
    ds_read_b64_tr_b16 v[170:171], v61 offset:16896
    ds_read_b64_tr_b16 v[176:177], v62 offset:16384
    ds_read_b64_tr_b16 v[178:179], v62 offset:16896
    ds_read_b64_tr_b16 v[184:185], v63 offset:16384
    ds_read_b64_tr_b16 v[186:187], v63 offset:16896
    v_mov_b64 v[64:65], 0
    v_mov_b64 v[66:67], 0
    v_mov_b64 v[72:73], 0
    v_mov_b64 v[74:75], 0
    v_mov_b64 v[80:81], 0
    v_mov_b64 v[82:83], 0
    v_mov_b64 v[88:89], 0
    v_mov_b64 v[90:91], 0
    v_mov_b64 v[96:97], 0
    v_mov_b64 v[98:99], 0
    v_mov_b64 v[104:105], 0
    v_mov_b64 v[106:107], 0
    v_mov_b64 v[112:113], 0
    v_mov_b64 v[114:115], 0
    v_mov_b64 v[120:121], 0
    v_mov_b64 v[122:123], 0
    v_lshrrev_b32 v40, 3, v0
    v_lshlrev_b32 v40, 5, v40
    v_and_b32_e64 v7, 1, v0
    v_lshl_add_u32 v40, v7, 4, v40
    v_bfe_u32 v7, v0, 1, 2
    v_lshl_add_u32 v40, v7, 2, v40
    s_mul_i32 s100, s60, 2112
    s_add_u32 s100, s100, 0x26600
    v_add_u32 v40, s100, v40
    v_lshrrev_b32 v42, 4, v0
    v_lshlrev_b32 v42, 5, v42
    v_and_b32 v7, 1, v0
    v_lshl_add_u32 v42, v7, 4, v42
    v_bfe_u32 v7, v0, 2, 2
    v_mul_u32_u24 v7, 2112, v7
    v_add_u32 v42, v42, v7
    v_add_u32 v42, 0x26600, v42
    v_mov_b32 v43, v42
    v_and_b32 v7, 2, v0
    v_cmp_eq_u32 vcc, 0, v7
    v_mov_b32 v7, 0x30000
    s_nop 0
    v_cndmask_b32 v42, v7, v42, vcc
    v_and_b32 v7, 2, v0
    v_cmp_eq_u32 vcc, 2, v7
    v_mov_b32 v7, 0x30000
    s_nop 0
    v_cndmask_b32_e64 v43, v7, v43, vcc
    s_add_u32 s67, s67, 0x20000
    s_and_b32 s67, s67, 0x1e0000
    s_or_b32 s68, s67, s65
    s_add_u32 m0, s66, 8192
    s_waitcnt lgkmcnt(1)
    s_waitcnt vmcnt(12)
    s_cmp_gt_u32 s90, 1
    s_cbranch_scc1 L_th_9
    s_waitcnt vmcnt(11)
    s_cmp_gt_u32 s90, 0
    s_cbranch_scc1 L_th_9
    s_waitcnt vmcnt(10)
L_th_9:
    buffer_load_dwordx4 v5, s[32:35], s68 offen offset:0 nt lds
    s_waitcnt vmcnt(12)
    s_cmp_gt_u32 s90, 1
    s_cbranch_scc1 L_th_10
    s_waitcnt vmcnt(11)
    s_cmp_gt_u32 s90, 0
    s_cbranch_scc1 L_th_10
    s_waitcnt vmcnt(4)
L_th_10:
    buffer_load_dwordx4 v6, s[32:35], s68 offen offset:1024 nt lds
    s_waitcnt vmcnt(12)
    s_cmp_gt_u32 s90, 1
    s_cbranch_scc1 L_th_11
    s_waitcnt vmcnt(5)
    s_cmp_gt_u32 s90, 0
    s_cbranch_scc1 L_th_11
    s_waitcnt vmcnt(4)
L_th_11:
    buffer_load_dwordx4 v5, s[32:35], s68 offen offset:2048 nt lds
    s_waitcnt vmcnt(6)
    s_cmp_gt_u32 s90, 1
    s_cbranch_scc1 L_th_12
    s_waitcnt vmcnt(5)
    s_cmp_gt_u32 s90, 0
    s_cbranch_scc1 L_th_12
    s_waitcnt vmcnt(4)
L_th_12:
    buffer_load_dwordx4 v6, s[32:35], s68 offen offset:3072 nt lds
    v_xor_b32 v5, 64, v5
    v_xor_b32 v6, 64, v6
    s_waitcnt vmcnt(8)
    v_add_f32 v28, v28, v29
    v_add_f32 v30, v30, v31
    v_add_f32 v28, v28, v30
    v_mul_f32 v36, 0xbb000000, v28
    v_add_f32 v32, v32, v33
    v_add_f32_e64 v34, v34, v35
    v_add_f32_e64 v32, v32, v34
    v_mul_f32 v37, 0xbb000000, v32
    v_mul_f32_e64 v38, s81, v36
    v_mul_f32_e64 v39, s81, v37
    v_dot2_f32_bf16 v38, v24, s6, v38
    v_dot2_f32_bf16 v39, v24, s7, v39
    v_dot2_f32_bf16 v38, v25, s6, v38
    v_dot2_f32_bf16 v39, v25, s7, v39
    v_dot2_f32_bf16 v38, v26, s6, v38
    v_dot2_f32_bf16 v39, v26, s7, v39
    v_dot2_f32_bf16 v38, v27, s6, v38
    v_dot2_f32_bf16 v39, v27, s7, v39
    s_nop 2
    v_cvt_pk_bf16_f32 v38, v38, v39
    ds_write_b32 v40, v38
    s_waitcnt lgkmcnt(0)
    s_barrier
    ds_read_b128 v[8:11], v42 offset:0
    ds_read_b128 v[12:15], v42 offset:128
    ds_read_b128 v[16:19], v43 offset:0
    ds_read_b128 v[20:23], v43 offset:128
    s_add_u32 s67, s67, 0x20000
    s_and_b32 s67, s67, 0x1e0000
    s_or_b32 s68, s67, s65
    s_add_u32 m0, s66, 12288
    s_waitcnt lgkmcnt(0)
    s_waitcnt vmcnt(6)
    s_cmp_gt_u32 s90, 1
    s_cbranch_scc1 L_th_13
    s_waitcnt vmcnt(5)
    s_cmp_gt_u32 s90, 0
    s_cbranch_scc1 L_th_13
    s_waitcnt vmcnt(4)
L_th_13:
    buffer_load_dwordx4 v5, s[32:35], s68 offen offset:0 nt lds
    v_smfmac_f32_16x16x64_bf16 v[64:67], v[8:11], a[0:7], v56
    v_smfmac_f32_16x16x64_bf16 v[64:67], v[12:15], a[8:15], v56
    v_smfmac_f32_16x16x64_bf16 v[64:67], v[16:19], a[16:23], v56
    v_smfmac_f32_16x16x64_bf16 v[64:67], v[20:23], a[24:31], v56
    v_smfmac_f32_16x16x64_bf16 v[72:75], v[8:11], a[32:39], v56
    v_smfmac_f32_16x16x64_bf16 v[72:75], v[12:15], a[40:47], v56
    v_smfmac_f32_16x16x64_bf16 v[72:75], v[16:19], a[48:55], v56
    v_smfmac_f32_16x16x64_bf16 v[72:75], v[20:23], a[56:63], v56
    v_smfmac_f32_16x16x64_bf16 v[80:83], v[8:11], a[64:71], v56
    v_smfmac_f32_16x16x64_bf16 v[80:83], v[12:15], a[72:79], v56
    s_nop 1
    v_add_f32 v64, v64, v65
    v_smfmac_f32_16x16x64_bf16 v[80:83], v[16:19], a[80:87], v56
    v_add_f32 v65, v66, v67
    v_smfmac_f32_16x16x64_bf16 v[80:83], v[20:23], a[88:95], v56
    s_waitcnt vmcnt(6)
    s_cmp_gt_u32 s90, 1
    s_cbranch_scc1 L_th_14
    s_waitcnt vmcnt(5)
    s_cmp_gt_u32 s90, 0
    s_cbranch_scc1 L_th_14
    s_waitcnt vmcnt(4)
L_th_14:
    buffer_load_dwordx4 v6, s[32:35], s68 offen offset:1024 nt lds
    v_add_f32_e64 v72, v72, v73
    v_smfmac_f32_16x16x64_bf16 v[88:91], v[8:11], a[96:103], v56
    v_max_f32 v7, v64, v65
    v_smfmac_f32_16x16x64_bf16 v[88:91], v[12:15], a[104:111], v56
    v_add_f32 v73, v74, v75
    v_smfmac_f32_16x16x64_bf16 v[88:91], v[16:19], a[112:119], v56
    v_add_f32 v80, v80, v81
    v_smfmac_f32_16x16x64_bf16 v[88:91], v[20:23], a[120:127], v56
    v_max3_f32 v7, v7, v72, v73
    v_smfmac_f32_16x16x64_bf16 v[96:99], v[8:11], a[160:167], v56
    v_add_f32 v81, v82, v83
    v_smfmac_f32_16x16x64_bf16 v[96:99], v[12:15], a[168:175], v56
    v_max3_f32 v7, v7, v80, v81
    v_smfmac_f32_16x16x64_bf16 v[96:99], v[16:19], a[176:183], v56
    s_waitcnt vmcnt(6)
    s_cmp_gt_u32 s90, 1
    s_cbranch_scc1 L_th_15
    s_waitcnt vmcnt(5)
    s_cmp_gt_u32 s90, 0
    s_cbranch_scc1 L_th_15
    s_waitcnt vmcnt(4)
L_th_15:
    buffer_load_dwordx4 v5, s[32:35], s68 offen offset:2048 nt lds
    v_add_f32 v88, v88, v89
    v_smfmac_f32_16x16x64_bf16 v[96:99], v[20:23], a[184:191], v56
    v_add_f32_e64 v89, v90, v91
    v_smfmac_f32_16x16x64_bf16 v[104:107], v[8:11], a[192:199], v56
    v_max3_f32 v7, v7, v88, v89
    v_smfmac_f32_16x16x64_bf16 v[104:107], v[12:15], a[200:207], v56
    v_smfmac_f32_16x16x64_bf16 v[104:107], v[16:19], a[208:215], v56
    v_smfmac_f32_16x16x64_bf16 v[104:107], v[20:23], a[216:223], v56
    s_nop 1
    v_add_f32 v96, v96, v97
    v_smfmac_f32_16x16x64_bf16 v[112:115], v[8:11], a[224:231], v56
    v_add_f32_e64 v97, v98, v99
    v_smfmac_f32_16x16x64_bf16 v[112:115], v[12:15], a[232:239], v56
    v_max3_f32 v7, v7, v96, v97
    v_smfmac_f32_16x16x64_bf16 v[112:115], v[16:19], a[240:247], v56
    s_waitcnt vmcnt(6)
    s_cmp_gt_u32 s90, 1
    s_cbranch_scc1 L_th_16
    s_waitcnt vmcnt(5)
    s_cmp_gt_u32 s90, 0
    s_cbranch_scc1 L_th_16
    s_waitcnt vmcnt(4)
L_th_16:
    buffer_load_dwordx4 v6, s[32:35], s68 offen offset:3072 nt lds
    v_add_f32 v104, v104, v105
    v_smfmac_f32_16x16x64_bf16 v[112:115], v[20:23], a[248:255], v56
    v_add_f32_e64 v105, v106, v107
    v_smfmac_f32_16x16x64_bf16 v[120:123], v[8:11], a[128:135], v56
    v_max3_f32 v7, v7, v104, v105
    v_smfmac_f32_16x16x64_bf16 v[120:123], v[12:15], a[136:143], v56
    v_smfmac_f32_16x16x64_bf16 v[120:123], v[16:19], a[144:151], v56
    v_smfmac_f32_16x16x64_bf16 v[120:123], v[20:23], a[152:159], v56
    s_nop 1
    v_add_f32 v112, v112, v113
    v_add_f32 v113, v114, v115
    v_max3_f32 v7, v7, v112, v113
    s_nop 2
    v_add_f32 v120, v120, v121
    v_add_f32 v121, v122, v123
    v_max3_f32 v7, v7, v120, v121
    v_xor_b32 v5, 64, v5
    v_xor_b32_e64 v6, 64, v6
    s_waitcnt vmcnt(8)
    ds_read_b64_tr_b16 v[132:133], v2 offset:0
    ds_read_b64_tr_b16 v[134:135], v2 offset:512
    ds_read_b64_tr_b16 v[140:141], v57 offset:0
    ds_read_b64_tr_b16 v[142:143], v57 offset:512
    ds_read_b64_tr_b16 v[148:149], v58 offset:0
    ds_read_b64_tr_b16 v[150:151], v58 offset:512
    ds_read_b64_tr_b16 v[156:157], v59 offset:0
    ds_read_b64_tr_b16 v[158:159], v59 offset:512
    ds_read_b64_tr_b16 v[164:165], v60 offset:0
    ds_read_b64_tr_b16 v[166:167], v60 offset:512
    ds_read_b64_tr_b16 v[172:173], v61 offset:0
    ds_read_b64_tr_b16 v[174:175], v61 offset:512
    ds_read_b64_tr_b16 v[180:181], v62 offset:0
    ds_read_b64_tr_b16 v[182:183], v62 offset:512
    ds_read_b64_tr_b16 v[188:189], v63 offset:0
    ds_read_b64_tr_b16 v[190:191], v63 offset:512
    v_mov_b32 v22, v1
    v_and_b32 v23, 15, v0
    v_cmp_eq_u32 vcc, 0, v23
    v_mov_b32 v23, 0x7fff0000
    s_nop 0
    v_cndmask_b32 v22, v23, v22, vcc
    s_lshl_b32 s100, s60, 11
    s_add_u32 s100, s100, 0x24000
    v_bfe_u32 v16, v0, 2, 2
    v_lshlrev_b32 v16, 6, v16
    v_lshrrev_b32 v23, 4, v0
    v_lshl_add_u32 v16, v23, 4, v16
    v_add_u32 v16, s100, v16
    v_lshl_add_u32 v17, v0, 2, s100
    v_and_b32 v23, 3, v0
    v_cmp_eq_u32 vcc, 0, v23
    v_mov_b32 v23, 0x30000
    s_nop 0
    v_cndmask_b32 v16, v23, v16, vcc
    s_add_u32 s67, s67, 0x20000
    s_and_b32 s67, s67, 0x1e0000
    s_or_b32 s68, s67, s65
    s_add_u32 m0, s66, 16384
    s_waitcnt lgkmcnt(0)
    s_waitcnt vmcnt(6)
    s_cmp_gt_u32 s90, 1
    s_cbranch_scc1 L_th_17
    s_waitcnt vmcnt(5)
    s_cmp_gt_u32 s90, 0
    s_cbranch_scc1 L_th_17
    s_waitcnt vmcnt(4)
L_th_17:
    buffer_load_dwordx4 v5, s[32:35], s68 offen offset:0 nt lds
    v_max_f32_dpp v7, v7, v7 row_ror:1 row_mask:0xf bank_mask:0xf
    s_mov_b32 s100, 0x3f803f80
    s_nop 0
    s_nop 0
    v_max_f32_dpp v7, v7, v7 row_ror:2 row_mask:0xf bank_mask:0xf
    s_nop 1
    v_max_f32_dpp v7, v7, v7 row_ror:4 row_mask:0xf bank_mask:0xf
    s_nop 1
    v_max_f32_dpp v7, v7, v7 row_ror:8 row_mask:0xf bank_mask:0xf
    v_mul_f32 v20, s82, v7
    v_pk_fma_f32 v[64:65], v[64:65], s[82:83], v[20:21] op_sel_hi:[1,0,0] neg_lo:[0,0,1] neg_hi:[0,0,1]
    v_pk_fma_f32 v[72:73], v[72:73], s[82:83], v[20:21] op_sel_hi:[1,0,0] neg_lo:[0,0,1] neg_hi:[0,0,1]
    v_exp_f32 v64, v64
    v_exp_f32_e64 v65, v65
    v_pk_fma_f32 v[80:81], v[80:81], s[82:83], v[20:21] op_sel_hi:[1,0,0] neg_lo:[0,0,1] neg_hi:[0,0,1]
    v_exp_f32 v72, v72
    v_exp_f32_e64 v73, v73
    v_pk_fma_f32 v[88:89], v[88:89], s[82:83], v[20:21] op_sel_hi:[1,0,0] neg_lo:[0,0,1] neg_hi:[0,0,1]
    s_waitcnt vmcnt(6)
    s_cmp_gt_u32 s90, 1
    s_cbranch_scc1 L_th_18
    s_waitcnt vmcnt(5)
    s_cmp_gt_u32 s90, 0
    s_cbranch_scc1 L_th_18
    s_waitcnt vmcnt(4)
L_th_18:
    buffer_load_dwordx4 v6, s[32:35], s68 offen offset:1024 nt lds
    v_pk_fma_f32 v[96:97], v[96:97], s[82:83], v[20:21] op_sel_hi:[1,0,0] neg_lo:[0,0,1] neg_hi:[0,0,1]
    v_pk_fma_f32 v[104:105], v[104:105], s[82:83], v[20:21] op_sel_hi:[1,0,0] neg_lo:[0,0,1] neg_hi:[0,0,1]
    v_pk_fma_f32 v[112:113], v[112:113], s[82:83], v[20:21] op_sel_hi:[1,0,0] neg_lo:[0,0,1] neg_hi:[0,0,1]
    v_pk_fma_f32 v[120:121], v[120:121], s[82:83], v[20:21] op_sel_hi:[1,0,0] neg_lo:[0,0,1] neg_hi:[0,0,1]
    v_cvt_pk_bf16_f32 v66, v64, v65
    v_exp_f32 v80, v80
    v_exp_f32 v81, v81
    v_cvt_pk_bf16_f32 v74, v72, v73
    v_exp_f32 v88, v88
    v_exp_f32 v89, v89
    v_dot2_f32_bf16 v21, v66, s100, 0
    v_cvt_pk_bf16_f32 v82, v80, v81
    v_exp_f32 v96, v96
    v_exp_f32_e64 v97, v97
    s_waitcnt vmcnt(6)
    s_cmp_gt_u32 s90, 1
    s_cbranch_scc1 L_th_19
    s_waitcnt vmcnt(5)
    s_cmp_gt_u32 s90, 0
    s_cbranch_scc1 L_th_19
    s_waitcnt vmcnt(4)
L_th_19:
    buffer_load_dwordx4 v5, s[32:35], s68 offen offset:2048 nt lds
    v_dot2_f32_bf16 v21, v74, s100, v21
    v_cvt_pk_bf16_f32 v90, v88, v89
    v_exp_f32 v104, v104
    v_exp_f32 v105, v105
    v_dot2_f32_bf16 v21, v82, s100, v21
    v_cvt_pk_bf16_f32 v98, v96, v97
    v_exp_f32 v112, v112
    v_exp_f32 v113, v113
    v_dot2_f32_bf16 v21, v90, s100, v21
    v_cvt_pk_bf16_f32 v106, v104, v105
    v_exp_f32 v120, v120
    v_exp_f32_e64 v121, v121
    v_dot2_f32_bf16 v21, v98, s100, v21
    v_cvt_pk_bf16_f32 v114, v112, v113
    s_waitcnt vmcnt(6)
    s_cmp_gt_u32 s90, 1
    s_cbranch_scc1 L_th_20
    s_waitcnt vmcnt(5)
    s_cmp_gt_u32 s90, 0
    s_cbranch_scc1 L_th_20
    s_waitcnt vmcnt(4)
L_th_20:
    buffer_load_dwordx4 v6, s[32:35], s68 offen offset:3072 nt lds
    v_dot2_f32_bf16 v21, v106, s100, v21
    v_cvt_pk_bf16_f32 v122, v120, v121
    v_dot2_f32_bf16 v21, v114, s100, v21
    v_dot2_f32_bf16 v21, v122, s100, v21
    ds_write2st64_b32 v17, v66, v74 offset0:0 offset1:1
    s_nop 1
    v_add_f32_dpp v21, v21, v21 row_ror:1 row_mask:0xf bank_mask:0xf
    s_nop 1
    v_add_f32_dpp v21, v21, v21 row_ror:2 row_mask:0xf bank_mask:0xf
    s_nop 1
    v_add_f32_dpp v21, v21, v21 row_ror:4 row_mask:0xf bank_mask:0xf
    s_nop 1
    v_add_f32_dpp v21, v21, v21 row_ror:8 row_mask:0xf bank_mask:0xf
    buffer_store_dwordx2 v[20:21], v22, s[40:43], s70 offen
    ds_write2st64_b32 v17, v82, v90 offset0:2 offset1:3
    buffer_store_dwordx2 v[20:21], v22, s[44:47], s70 offen sc1
    ds_write2st64_b32 v17, v98, v106 offset0:4 offset1:5
    ds_write2st64_b32 v17, v114, v122 offset0:6 offset1:7
    v_xor_b32_e64 v5, 64, v5
    v_xor_b32_e64 v6, 64, v6
    s_cmp_eq_u32 s60, 1
    s_cbranch_scc0 L_tka1
    v_mov_b32_e64 v71, 1
    buffer_atomic_add v71, v77, s[24:27], s91 offen sc0 sc1
    s_add_u32 s91, s91, 4096
L_tka1:
    s_add_u32 s67, s67, 0x20000
    s_and_b32 s67, s67, 0x1e0000
    s_or_b32 s68, s67, s65
    s_add_u32 m0, s66, 20480
    s_waitcnt lgkmcnt(1)
    s_waitcnt vmcnt(8)
    s_cmp_gt_u32 s90, 1
    s_cbranch_scc1 L_th_21
    s_waitcnt vmcnt(7)
    s_cmp_gt_u32 s90, 0
    s_cbranch_scc1 L_th_21
    s_waitcnt vmcnt(6)
L_th_21:
    buffer_load_dwordx4 v5, s[32:35], s68 offen offset:0 nt lds
    s_waitcnt vmcnt(8)
    s_cmp_gt_u32 s90, 1
    s_cbranch_scc1 L_th_22
    s_waitcnt vmcnt(7)
    s_cmp_gt_u32 s90, 0
    s_cbranch_scc1 L_th_22
    s_waitcnt vmcnt(6)
L_th_22:
    buffer_load_dwordx4 v6, s[32:35], s68 offen offset:1024 nt lds
    s_waitcnt vmcnt(8)
    s_cmp_gt_u32 s90, 1
    s_cbranch_scc1 L_th_23
    s_waitcnt vmcnt(7)
    s_cmp_gt_u32 s90, 0
    s_cbranch_scc1 L_th_23
    s_waitcnt vmcnt(6)
L_th_23:
    buffer_load_dwordx4 v5, s[32:35], s68 offen offset:2048 nt lds
    s_waitcnt vmcnt(8)
    s_cmp_gt_u32 s90, 1
    s_cbranch_scc1 L_th_24
    s_waitcnt vmcnt(7)
    s_cmp_gt_u32 s90, 0
    s_cbranch_scc1 L_th_24
    s_waitcnt vmcnt(6)
L_th_24:
    buffer_load_dwordx4 v6, s[32:35], s68 offen offset:3072 nt lds
    v_xor_b32 v5, 64, v5
    v_xor_b32_e64 v6, 64, v6
    s_waitcnt vmcnt(10)
    ds_read_b64_tr_b16 v[192:193], v2 offset:8192
    ds_read_b64_tr_b16 v[194:195], v2 offset:8704
    ds_read_b64_tr_b16 v[200:201], v57 offset:8192
    ds_read_b64_tr_b16 v[202:203], v57 offset:8704
    ds_read_b64_tr_b16 v[208:209], v58 offset:8192
    ds_read_b64_tr_b16 v[210:211], v58 offset:8704
    ds_read_b64_tr_b16 v[216:217], v59 offset:8192
    ds_read_b64_tr_b16 v[218:219], v59 offset:8704
    ds_read_b64_tr_b16 v[224:225], v60 offset:8192
    ds_read_b64_tr_b16 v[226:227], v60 offset:8704
    ds_read_b64_tr_b16 v[232:233], v61 offset:8192
    ds_read_b64_tr_b16 v[234:235], v61 offset:8704
    ds_read_b64_tr_b16 v[240:241], v62 offset:8192
    ds_read_b64_tr_b16 v[242:243], v62 offset:8704
    ds_read_b64_tr_b16 v[248:249], v63 offset:8192
    ds_read_b64_tr_b16 v[250:251], v63 offset:8704
    ds_read_b128 v[8:11], v16 offset:0
    s_nop 0
    s_waitcnt lgkmcnt(0)
    v_mfma_f32_16x16x32_bf16 v[24:27], v[8:11], v[128:131], 0
    v_mfma_f32_16x16x32_bf16 v[28:31], v[8:11], v[136:139], 0
    v_mfma_f32_16x16x32_bf16 v[32:35], v[8:11], v[144:147], 0
    v_mfma_f32_16x16x32_bf16 v[36:39], v[8:11], v[152:155], 0
    v_mfma_f32_16x16x32_bf16 v[40:43], v[8:11], v[160:163], 0
    v_mfma_f32_16x16x32_bf16 v[44:47], v[8:11], v[168:171], 0
    v_mfma_f32_16x16x32_bf16 v[48:51], v[8:11], v[176:179], 0
    v_mfma_f32_16x16x32_bf16 v[52:55], v[8:11], v[184:187], 0
    ds_read_b128 v[12:15], v16 offset:256
    s_waitcnt lgkmcnt(0)
    v_mfma_f32_16x16x32_bf16 v[24:27], v[12:15], v[132:135], v[24:27]
    s_nop 0
    v_mfma_f32_16x16x32_bf16 v[28:31], v[12:15], v[140:143], v[28:31]
    v_mfma_f32_16x16x32_bf16 v[32:35], v[12:15], v[148:151], v[32:35]
    v_mfma_f32_16x16x32_bf16 v[36:39], v[12:15], v[156:159], v[36:39]
    v_mfma_f32_16x16x32_bf16 v[40:43], v[12:15], v[164:167], v[40:43]
    v_mfma_f32_16x16x32_bf16 v[44:47], v[12:15], v[172:175], v[44:47]
    v_mfma_f32_16x16x32_bf16 v[48:51], v[12:15], v[180:183], v[48:51]
    v_mfma_f32_16x16x32_bf16 v[52:55], v[12:15], v[188:191], v[52:55]
    s_add_u32 s67, s67, 0x20000
    s_and_b32 s67, s67, 0x1e0000
    s_or_b32 s68, s67, s65
    s_add_u32 m0, s66, 0
    s_waitcnt lgkmcnt(1)
    s_waitcnt vmcnt(8)
    s_cmp_gt_u32 s90, 1
    s_cbranch_scc1 L_th_25
    s_waitcnt vmcnt(7)
    s_cmp_gt_u32 s90, 0
    s_cbranch_scc1 L_th_25
    s_waitcnt vmcnt(6)
L_th_25:
    buffer_load_dwordx4 v5, s[32:35], s68 offen offset:0 nt lds
    s_waitcnt vmcnt(8)
    s_cmp_gt_u32 s90, 1
    s_cbranch_scc1 L_th_26
    s_waitcnt vmcnt(7)
    s_cmp_gt_u32 s90, 0
    s_cbranch_scc1 L_th_26
    s_waitcnt vmcnt(4)
L_th_26:
    buffer_load_dwordx4 v6, s[32:35], s68 offen offset:1024 nt lds
    s_waitcnt vmcnt(8)
    s_cmp_gt_u32 s90, 1
    s_cbranch_scc1 L_th_27
    s_waitcnt vmcnt(5)
    s_cmp_gt_u32 s90, 0
    s_cbranch_scc1 L_th_27
    s_waitcnt vmcnt(4)
L_th_27:
    buffer_load_dwordx4 v5, s[32:35], s68 offen offset:2048 nt lds
    s_waitcnt vmcnt(6)
    s_cmp_gt_u32 s90, 1
    s_cbranch_scc1 L_th_28
    s_waitcnt vmcnt(5)
    s_cmp_gt_u32 s90, 0
    s_cbranch_scc1 L_th_28
    s_waitcnt vmcnt(4)
L_th_28:
    buffer_load_dwordx4 v6, s[32:35], s68 offen offset:3072 nt lds
    v_xor_b32 v5, 64, v5
    v_xor_b32 v6, 64, v6
    ds_read_b128 v[8:11], v16 offset:512
    s_waitcnt lgkmcnt(0)
    v_mfma_f32_16x16x32_bf16 v[24:27], v[8:11], v[192:195], v[24:27]
    v_mfma_f32_16x16x32_bf16 v[28:31], v[8:11], v[200:203], v[28:31]
    v_mfma_f32_16x16x32_bf16 v[32:35], v[8:11], v[208:211], v[32:35]
    v_mfma_f32_16x16x32_bf16 v[36:39], v[8:11], v[216:219], v[36:39]
    v_mfma_f32_16x16x32_bf16 v[40:43], v[8:11], v[224:227], v[40:43]
    v_mfma_f32_16x16x32_bf16 v[44:47], v[8:11], v[232:235], v[44:47]
    v_mfma_f32_16x16x32_bf16 v[48:51], v[8:11], v[240:243], v[48:51]
    v_mfma_f32_16x16x32_bf16 v[52:55], v[8:11], v[248:251], v[52:55]
    s_cmp_eq_u32 s60, 1
    s_cbranch_scc0 L_tkb1
    s_waitcnt vmcnt(8)
    v_readfirstlane_b32 s4, v71
    s_nop 0
    s_add_u32 s4, s4, 1
    v_mov_b32 v71, s4
    ds_write_b32 v70, v71
L_tkb1:
    s_getpc_b64 s[4:5]
L_pc1:
    s_add_u32 s4, s4, L_tail-L_pc1
    s_addc_u32 s5, s5, 0
    s_lshl_b32 s100, s62, 9
    s_lshl_b32 s101, s60, 7
    s_add_u32 s100, s100, s101
    s_min_u32 s100, s100, L_codeend-L_tail-4
    v_mov_b32_e64 v96, s100
    global_load_dword v96, v96, s[4:5]
    s_add_u32 s67, s67, 0x20000
    s_and_b32 s67, s67, 0x1e0000
    s_nop 0
    s_or_b32 s68, s67, s65
    s_add_u32 m0, s66, 4096
    s_waitcnt lgkmcnt(1)
    s_waitcnt vmcnt(7)
    s_cmp_gt_u32 s90, 1
    s_cbranch_scc1 L_th_29
    s_waitcnt vmcnt(6)
    s_cmp_gt_u32 s90, 0
    s_cbranch_scc1 L_th_29
    s_waitcnt vmcnt(5)
L_th_29:
    buffer_load_dwordx4 v5, s[32:35], s68 offen offset:0 nt lds
    s_waitcnt vmcnt(7)
    s_cmp_gt_u32 s90, 1
    s_cbranch_scc1 L_th_30
    s_waitcnt vmcnt(6)
    s_cmp_gt_u32 s90, 0
    s_cbranch_scc1 L_th_30
    s_waitcnt vmcnt(5)
L_th_30:
    buffer_load_dwordx4 v6, s[32:35], s68 offen offset:1024 nt lds
    s_waitcnt vmcnt(7)
    s_cmp_gt_u32 s90, 1
    s_cbranch_scc1 L_th_31
    s_waitcnt vmcnt(6)
    s_cmp_gt_u32 s90, 0
    s_cbranch_scc1 L_th_31
    s_waitcnt vmcnt(5)
L_th_31:
    buffer_load_dwordx4 v5, s[32:35], s68 offen offset:2048 nt lds
    s_waitcnt vmcnt(7)
    s_cmp_gt_u32 s90, 1
    s_cbranch_scc1 L_th_32
    s_waitcnt vmcnt(6)
    s_cmp_gt_u32 s90, 0
    s_cbranch_scc1 L_th_32
    s_waitcnt vmcnt(5)
L_th_32:
    buffer_load_dwordx4 v6, s[32:35], s68 offen offset:3072 nt lds
    v_xor_b32 v5, 64, v5
    v_xor_b32_e64 v6, 64, v6
    ds_read_b32 v76, v70
    s_waitcnt lgkmcnt(0)
    v_readfirstlane_b32 s4, v76
    s_nop 0
    s_cmp_ge_u32 s4, 3
    s_cselect_b32 s90, 1, 0
    s_cmp_ge_u32 s4, 6
    s_addc_u32 s90, s90, 0
    s_waitcnt vmcnt(9)
    ds_read_b64_tr_b16 v[196:197], v2 offset:16384
    ds_read_b64_tr_b16 v[198:199], v2 offset:16896
    ds_read_b64_tr_b16 v[204:205], v57 offset:16384
    ds_read_b64_tr_b16 v[206:207], v57 offset:16896
    ds_read_b64_tr_b16 v[212:213], v58 offset:16384
    ds_read_b64_tr_b16 v[214:215], v58 offset:16896
    ds_read_b64_tr_b16 v[220:221], v59 offset:16384
    ds_read_b64_tr_b16 v[222:223], v59 offset:16896
    ds_read_b64_tr_b16 v[228:229], v60 offset:16384
    ds_read_b64_tr_b16 v[230:231], v60 offset:16896
    ds_read_b64_tr_b16 v[236:237], v61 offset:16384
    ds_read_b64_tr_b16 v[238:239], v61 offset:16896
    ds_read_b64_tr_b16 v[244:245], v62 offset:16384
    ds_read_b64_tr_b16 v[246:247], v62 offset:16896
    ds_read_b64_tr_b16 v[252:253], v63 offset:16384
    ds_read_b64_tr_b16 v[254:255], v63 offset:16896
    ds_read_b128 v[12:15], v16 offset:768
    s_nop 0
    s_waitcnt lgkmcnt(0)
    v_mfma_f32_16x16x32_bf16 v[24:27], v[12:15], v[196:199], v[24:27]
    v_mfma_f32_16x16x32_bf16 v[28:31], v[12:15], v[204:207], v[28:31]
    v_mfma_f32_16x16x32_bf16 v[32:35], v[12:15], v[212:215], v[32:35]
    v_mfma_f32_16x16x32_bf16 v[36:39], v[12:15], v[220:223], v[36:39]
    v_mfma_f32_16x16x32_bf16 v[40:43], v[12:15], v[228:231], v[40:43]
    v_mfma_f32_16x16x32_bf16 v[44:47], v[12:15], v[236:239], v[44:47]
    v_mfma_f32_16x16x32_bf16 v[48:51], v[12:15], v[244:247], v[48:51]
    v_mfma_f32_16x16x32_bf16 v[52:55], v[12:15], v[252:255], v[52:55]
    v_mov_b32 v80, -1
    v_mov_b32 v81, -1
    v_mov_b32 v82, -1
    v_mov_b32 v83, -1
    s_lshl_b32 s100, s61, 17
    s_mul_i32 s101, s62, 1408
    s_add_u32 s100, s100, s101
    s_mul_i32 s101, s60, 352
    s_add_u32 s100, s100, s101
    s_add_u32 s100, s100, 0x9000
    v_mov_b32 v88, v1
    v_cmp_gt_u32_e64 vcc, 22, v0
    v_mov_b32 v89, 0x7fff0000
    s_nop 0
    v_cndmask_b32_e64 v88, v89, v88, vcc
    buffer_store_dwordx4 v[80:83], v88, s[40:43], s100 offen
    s_cmp_eq_u32 s42, 0
    s_cbranch_scc1 L_slow7
L_slow7_b:
    s_lshl_b32 s100, s61, 17
    s_mul_i32 s101, s62, 1920
    s_add_u32 s100, s100, s101
    s_mul_i32 s101, s60, 480
    s_add_u32 s100, s100, s101
    s_add_u32 s100, s100, 0x100000
    v_mov_b32 v90, v1
    v_cmp_gt_u32 vcc, 30, v0
    v_mov_b32 v89, 0x7fff0000
    s_nop 0
    v_cndmask_b32 v90, v89, v90, vcc
    buffer_store_dwordx4 v[80:83], v90, s[40:43], s100 offen
    s_cmp_eq_u32 s42, 0
    s_cbranch_scc1 L_slow8
L_slow8_b:
    s_add_u32 s67, s67, 0x20000
    s_and_b32 s67, s67, 0x1e0000
    s_or_b32 s68, s67, s65
    s_add_u32 m0, s66, 8192
    s_waitcnt lgkmcnt(1)
    s_waitcnt vmcnt(9)
    s_cmp_gt_u32 s90, 1
    s_cbranch_scc1 L_th_33
    s_waitcnt vmcnt(8)
    s_cmp_gt_u32 s90, 0
    s_cbranch_scc1 L_th_33
    s_waitcnt vmcnt(7)
L_th_33:
    buffer_load_dwordx4 v5, s[32:35], s68 offen offset:0 nt lds
    s_waitcnt vmcnt(9)
    s_cmp_gt_u32 s90, 1
    s_cbranch_scc1 L_th_34
    s_waitcnt vmcnt(8)
    s_cmp_gt_u32 s90, 0
    s_cbranch_scc1 L_th_34
    s_waitcnt vmcnt(6)
L_th_34:
    buffer_load_dwordx4 v6, s[32:35], s68 offen offset:1024 nt lds
    s_waitcnt vmcnt(9)
    s_cmp_gt_u32 s90, 1
    s_cbranch_scc1 L_th_35
    s_waitcnt vmcnt(7)
    s_cmp_gt_u32 s90, 0
    s_cbranch_scc1 L_th_35
    s_waitcnt vmcnt(6)
L_th_35:
    buffer_load_dwordx4 v5, s[32:35], s68 offen offset:2048 nt lds
    s_waitcnt vmcnt(8)
    s_cmp_gt_u32 s90, 1
    s_cbranch_scc1 L_th_36
    s_waitcnt vmcnt(7)
    s_cmp_gt_u32 s90, 0
    s_cbranch_scc1 L_th_36
    s_waitcnt vmcnt(6)
L_th_36:
    buffer_load_dwordx4 v6, s[32:35], s68 offen offset:3072 nt lds
    v_xor_b32 v5, 64, v5
    v_xor_b32_e64 v6, 64, v6
    s_add_u32 s67, s67, 0x20000
    s_and_b32 s67, s67, 0x1e0000
    s_or_b32 s68, s67, s65
    s_add_u32 m0, s66, 12288
    s_waitcnt lgkmcnt(1)
    s_waitcnt vmcnt(8)
    s_cmp_gt_u32 s90, 1
    s_cbranch_scc1 L_th_37
    s_waitcnt vmcnt(7)
    s_cmp_gt_u32 s90, 0
    s_cbranch_scc1 L_th_37
    s_waitcnt vmcnt(6)
L_th_37:
    buffer_load_dwordx4 v5, s[32:35], s68 offen offset:0 nt lds
    s_waitcnt vmcnt(8)
    s_cmp_gt_u32 s90, 1
    s_cbranch_scc1 L_th_38
    s_waitcnt vmcnt(7)
    s_cmp_gt_u32 s90, 0
    s_cbranch_scc1 L_th_38
    s_waitcnt vmcnt(4)
L_th_38:
    buffer_load_dwordx4 v6, s[32:35], s68 offen offset:1024 nt lds
    s_waitcnt vmcnt(8)
    s_cmp_gt_u32 s90, 1
    s_cbranch_scc1 L_th_39
    s_waitcnt vmcnt(5)
    s_cmp_gt_u32 s90, 0
    s_cbranch_scc1 L_th_39
    s_waitcnt vmcnt(4)
L_th_39:
    buffer_load_dwordx4 v5, s[32:35], s68 offen offset:2048 nt lds
    s_waitcnt vmcnt(6)
    s_cmp_gt_u32 s90, 1
    s_cbranch_scc1 L_th_40
    s_waitcnt vmcnt(5)
    s_cmp_gt_u32 s90, 0
    s_cbranch_scc1 L_th_40
    s_waitcnt vmcnt(4)
L_th_40:
    buffer_load_dwordx4 v6, s[32:35], s68 offen offset:3072 nt lds
    v_xor_b32 v5, 64, v5
    v_xor_b32 v6, 64, v6
    s_waitcnt vmcnt(10)
    ds_read_b64_tr_b16 v[68:69], v2 offset:0
    ds_read_b64_tr_b16 v[70:71], v2 offset:512
    ds_read_b64_tr_b16 v[76:77], v57 offset:0
    ds_read_b64_tr_b16 v[78:79], v57 offset:512
    ds_read_b64_tr_b16 v[84:85], v58 offset:0
    ds_read_b64_tr_b16 v[86:87], v58 offset:512
    ds_read_b64_tr_b16 v[92:93], v59 offset:0
    ds_read_b64_tr_b16 v[94:95], v59 offset:512
    ds_read_b64_tr_b16 v[100:101], v60 offset:0
    ds_read_b64_tr_b16 v[102:103], v60 offset:512
    ds_read_b64_tr_b16 v[108:109], v61 offset:0
    ds_read_b64_tr_b16 v[110:111], v61 offset:512
    ds_read_b64_tr_b16 v[116:117], v62 offset:0
    ds_read_b64_tr_b16 v[118:119], v62 offset:512
    ds_read_b64_tr_b16 v[124:125], v63 offset:0
    ds_read_b64_tr_b16 v[126:127], v63 offset:512
    ds_read_b128 v[8:11], v16 offset:1792
    s_waitcnt lgkmcnt(0)
    s_nop 0
    v_mfma_f32_16x16x32_bf16 v[24:27], v[8:11], v[68:71], v[24:27]
    v_mfma_f32_16x16x32_bf16 v[28:31], v[8:11], v[76:79], v[28:31]
    v_mfma_f32_16x16x32_bf16 v[32:35], v[8:11], v[84:87], v[32:35]
    v_mfma_f32_16x16x32_bf16 v[36:39], v[8:11], v[92:95], v[36:39]
    v_mfma_f32_16x16x32_bf16 v[40:43], v[8:11], v[100:103], v[40:43]
    v_mfma_f32_16x16x32_bf16 v[44:47], v[8:11], v[108:111], v[44:47]
    v_mfma_f32_16x16x32_bf16 v[48:51], v[8:11], v[116:119], v[48:51]
    v_mfma_f32_16x16x32_bf16 v[52:55], v[8:11], v[124:127], v[52:55]
    buffer_load_dwordx4 v[64:67], v1, s[36:39], s71 offen offset:0 sc1
    v_and_b32 v74, 7, v0
    v_lshlrev_b32 v74, 2, v74
    buffer_load_dword v74, v74, s[52:55], 0 offen offset:32 sc1
    s_add_u32 s67, s67, 0x20000
    s_and_b32 s67, s67, 0x1e0000
    s_or_b32 s68, s67, s65
    s_add_u32 m0, s66, 16384
    s_waitcnt lgkmcnt(1)
    s_waitcnt vmcnt(8)
    s_cmp_gt_u32 s90, 1
    s_cbranch_scc1 L_th_41
    s_waitcnt vmcnt(7)
    s_cmp_gt_u32 s90, 0
    s_cbranch_scc1 L_th_41
    s_waitcnt vmcnt(6)
L_th_41:
    buffer_load_dwordx4 v5, s[32:35], s68 offen offset:0 nt lds
    s_waitcnt vmcnt(8)
    s_cmp_gt_u32 s90, 1
    s_cbranch_scc1 L_th_42
    s_waitcnt vmcnt(7)
    s_cmp_gt_u32 s90, 0
    s_cbranch_scc1 L_th_42
    s_waitcnt vmcnt(6)
L_th_42:
    buffer_load_dwordx4 v6, s[32:35], s68 offen offset:1024 nt lds
    s_waitcnt vmcnt(8)
    s_cmp_gt_u32 s90, 1
    s_cbranch_scc1 L_th_43
    s_waitcnt vmcnt(7)
    s_cmp_gt_u32 s90, 0
    s_cbranch_scc1 L_th_43
    s_waitcnt vmcnt(6)
L_th_43:
    buffer_load_dwordx4 v5, s[32:35], s68 offen offset:2048 nt lds
    s_waitcnt vmcnt(8)
    s_cmp_gt_u32 s90, 1
    s_cbranch_scc1 L_th_44
    s_waitcnt vmcnt(7)
    s_cmp_gt_u32 s90, 0
    s_cbranch_scc1 L_th_44
    s_waitcnt vmcnt(6)
L_th_44:
    buffer_load_dwordx4 v6, s[32:35], s68 offen offset:3072 nt lds
    v_xor_b32 v5, 64, v5
    v_xor_b32 v6, 64, v6
    v_lshrrev_b32_e64 v18, 5, v0
    v_lshlrev_b32_e64 v18, 14, v18
    v_bfe_u32 v19, v0, 3, 2
    v_lshl_add_u32 v18, v19, 10, v18
    v_and_b32_e64 v19, 7, v0
    v_lshl_add_u32 v18, v19, 4, v18
    s_mov_b32 s96, s12
    s_mov_b32 s97, s13
    s_mov_b32 s98, 0x400000
    s_mov_b32 s99, 0x20000
    s_lshl_b32 s86, s61, 19
    s_lshl_b32 s101, s63, 17
    s_add_u32 s86, s86, s101
    s_lshl_b32 s101, s60, 12
    s_add_u32 s86, s86, s101
    s_lshl_b32 s101, s64, 7
    s_add_u32 s86, s86, s101
    s_lshl_b32 s87, s60, 12
    s_add_u32 s87, s87, 0x1c000
    v_and_b32_e64 v19, 32, v0
    v_xor_b32_e64 v18, v18, v19
    v_xor_b32_e64 v19, 64, v18
    s_add_u32 s67, s67, 0x20000
    s_and_b32 s67, s67, 0x1e0000
    s_or_b32 s68, s67, s65
    s_add_u32 m0, s66, 20480
    s_waitcnt lgkmcnt(1)
    s_waitcnt vmcnt(8)
    s_cmp_gt_u32 s90, 1
    s_cbranch_scc1 L_th_45
    s_waitcnt vmcnt(7)
    s_cmp_gt_u32 s90, 0
    s_cbranch_scc1 L_th_45
    s_waitcnt vmcnt(6)
L_th_45:
    buffer_load_dwordx4 v5, s[32:35], s68 offen offset:0 nt lds
    s_waitcnt vmcnt(8)
    s_cmp_gt_u32 s90, 1
    s_cbranch_scc1 L_th_46
    s_waitcnt vmcnt(7)
    s_cmp_gt_u32 s90, 0
    s_cbranch_scc1 L_th_46
    s_waitcnt vmcnt(4)
L_th_46:
    buffer_load_dwordx4 v6, s[32:35], s68 offen offset:1024 nt lds
    s_waitcnt vmcnt(8)
    s_cmp_gt_u32 s90, 1
    s_cbranch_scc1 L_th_47
    s_waitcnt vmcnt(5)
    s_cmp_gt_u32 s90, 0
    s_cbranch_scc1 L_th_47
    s_waitcnt vmcnt(4)
L_th_47:
    buffer_load_dwordx4 v5, s[32:35], s68 offen offset:2048 nt lds
    s_waitcnt vmcnt(6)
    s_cmp_gt_u32 s90, 1
    s_cbranch_scc1 L_th_48
    s_waitcnt vmcnt(5)
    s_cmp_gt_u32 s90, 0
    s_cbranch_scc1 L_th_48
    s_waitcnt vmcnt(4)
L_th_48:
    buffer_load_dwordx4 v6, s[32:35], s68 offen offset:3072 nt lds
    v_xor_b32 v5, 64, v5
    v_xor_b32_e64 v6, 64, v6
    s_waitcnt vmcnt(8)
    s_branch L_f1_c
L_f1_s:
    s_sleep 8
    v_and_b32_e64 v74, 7, v0
    v_lshlrev_b32 v74, 2, v74
    buffer_load_dword v74, v74, s[52:55], 0 offen offset:32 sc1
    s_add_u32 s94, s94, 1
    s_cmp_lt_u32 s94, 0x40000
    s_waitcnt vmcnt(0)
    s_cbranch_scc0 L_f1_d
L_f1_c:
    v_cmp_eq_u32 vcc, 0, v74
    s_cbranch_vccnz L_f1_s
L_f1_d:
    v_add_u32_dpp v74, v74, v74 row_ror:1 row_mask:0xf bank_mask:0xf
    s_nop 1
    v_add_u32_dpp v74, v74, v74 row_ror:2 row_mask:0xf bank_mask:0xf
    s_nop 1
    v_add_u32_dpp v74, v74, v74 row_ror:4 row_mask:0xf bank_mask:0xf
    s_nop 0
    v_readfirstlane_b32 s100, v74
    s_nop 0
    s_cmpk_ge_u32 s100, 512
    s_cselect_b32 s100, 0, 4
    s_xor_b32 s100, s100, s22
    s_bitcmp1_b32 s100, 2
    s_cselect_b32 s100, 0x2000, 0
    s_add_u32 s75, s75, s100
    s_add_u32 s23, s74, s100
    s_xor_b32 s74, s23, 0x2000
    s_branch L_ml1_c
L_ml1_r:
    buffer_load_dwordx4 v[64:67], v1, s[36:39], s71 offen offset:0 sc1
    s_add_u32 s94, s94, 1
    s_cmp_lt_u32 s94, 0x40000
    s_cselect_b32 s95, -2, -1
    s_waitcnt vmcnt(0)
L_ml1_c:
    s_waitcnt vmcnt(8)
    v_max3_u32 v73, v64, v65, v66
    v_max_u32 v73, v73, v67
    v_cmp_lt_u32 vcc, s95, v73
    s_cbranch_vccnz L_ml1_r
    v_sub_f32 v64, v64, v20
    v_sub_f32_e64 v66, v66, v20
    v_exp_f32 v64, v64
    v_exp_f32_e64 v66, v66
    v_mul_f32_e64 v7, v64, v65
    v_fmac_f32_e64 v7, v66, v67
    s_nop 1
    v_add_f32_dpp v7, v7, v7 row_ror:1 row_mask:0xf bank_mask:0xf
    s_nop 1
    v_add_f32_dpp v7, v7, v7 row_ror:2 row_mask:0xf bank_mask:0xf
    s_nop 1
    v_add_f32_dpp v7, v7, v7 row_ror:4 row_mask:0xf bank_mask:0xf
    s_nop 1
    v_add_f32_dpp v7, v7, v7 row_ror:8 row_mask:0xf bank_mask:0xf
    v_rcp_f32 v7, v7
    s_lshl_b32 s4, s60, 9
    s_add_u32 s4, s4, 0x26000
    v_and_b32 v22, 48, v0
    v_mul_u32_u24 v22, 112, v22
    v_add3_u32 v22, v22, v1, s4
    s_mov_b32 s69, 1
    s_lshr_b32 s100, s61, 1
    s_mul_i32 s100, s100, 7
    s_and_b32 s68, s61, 1
    s_lshl_b32 s68, s68, 2
    s_add_u32 s100, s100, s68
    s_add_u32 s100, s100, s63
    s_lshl_b32 s8, s100, 16
    s_lshl_b32 s101, s60, 14
    s_add_u32 s8, s8, s101
    s_lshl_b32 s101, s64, 7
    s_add_u32 s8, s8, s101
    s_lshl_b32 s9, s60, 11
    s_add_u32 s9, s9, 0x24000
    s_bitcmp1_b32 s15, 1
    s_cselect_b32 s100, 0x1c0000, 0
    s_mov_b32 s56, s20
    s_mov_b32 s57, s21
    s_mov_b32 s58, s100
    s_mov_b32 s59, 0x20000
    s_add_u32 s67, s67, 0x20000
    s_and_b32 s67, s67, 0x1e0000
    s_or_b32 s68, s67, s65
    s_add_u32 m0, s66, 0
    s_waitcnt lgkmcnt(1)
    s_waitcnt vmcnt(6)
    s_cmp_gt_u32 s90, 1
    s_cbranch_scc1 L_th_49
    s_waitcnt vmcnt(5)
    s_cmp_gt_u32 s90, 0
    s_cbranch_scc1 L_th_49
    s_waitcnt vmcnt(4)
L_th_49:
    buffer_load_dwordx4 v5, s[32:35], s68 offen offset:0 nt lds
    s_waitcnt vmcnt(6)
    s_cmp_gt_u32 s90, 1
    s_cbranch_scc1 L_th_50
    s_waitcnt vmcnt(5)
    s_cmp_gt_u32 s90, 0
    s_cbranch_scc1 L_th_50
    s_waitcnt vmcnt(4)
L_th_50:
    buffer_load_dwordx4 v6, s[32:35], s68 offen offset:1024 nt lds
    s_waitcnt vmcnt(6)
    s_cmp_gt_u32 s90, 1
    s_cbranch_scc1 L_th_51
    s_waitcnt vmcnt(5)
    s_cmp_gt_u32 s90, 0
    s_cbranch_scc1 L_th_51
    s_waitcnt vmcnt(4)
L_th_51:
    buffer_load_dwordx4 v5, s[32:35], s68 offen offset:2048 nt lds
    s_waitcnt vmcnt(6)
    s_cmp_gt_u32 s90, 1
    s_cbranch_scc1 L_th_52
    s_waitcnt vmcnt(5)
    s_cmp_gt_u32 s90, 0
    s_cbranch_scc1 L_th_52
    s_waitcnt vmcnt(4)
L_th_52:
    buffer_load_dwordx4 v6, s[32:35], s68 offen offset:3072 nt lds
    v_xor_b32_e64 v5, 64, v5
    v_xor_b32 v6, 64, v6
    ds_read_b128 v[12:15], v16 offset:1024
    s_waitcnt vmcnt(14)
    ds_read_b64_tr_b16 v[64:65], v2 offset:8192
    ds_read_b64_tr_b16 v[66:67], v2 offset:8704
    ds_read_b64_tr_b16 v[72:73], v57 offset:8192
    ds_read_b64_tr_b16 v[74:75], v57 offset:8704
    ds_read_b64_tr_b16 v[80:81], v58 offset:8192
    ds_read_b64_tr_b16 v[82:83], v58 offset:8704
    ds_read_b64_tr_b16 v[88:89], v59 offset:8192
    ds_read_b64_tr_b16 v[90:91], v59 offset:8704
    ds_read_b64_tr_b16 v[96:97], v60 offset:8192
    ds_read_b64_tr_b16 v[98:99], v60 offset:8704
    ds_read_b64_tr_b16 v[104:105], v61 offset:8192
    s_waitcnt lgkmcnt(9)
    v_mfma_f32_16x16x32_bf16 v[24:27], v[12:15], v[64:67], v[24:27]
    s_nop 0
    ds_read_b64_tr_b16 v[106:107], v61 offset:8704
    ds_read_b64_tr_b16 v[112:113], v62 offset:8192
    s_waitcnt lgkmcnt(9)
    v_mfma_f32_16x16x32_bf16 v[28:31], v[12:15], v[72:75], v[28:31]
    s_nop 0
    ds_read_b64_tr_b16 v[114:115], v62 offset:8704
    ds_read_b64_tr_b16 v[120:121], v63 offset:8192
    s_waitcnt lgkmcnt(9)
    v_mfma_f32_16x16x32_bf16 v[32:35], v[12:15], v[80:83], v[32:35]
    ds_read_b64_tr_b16 v[122:123], v63 offset:8704
    s_waitcnt lgkmcnt(8)
    v_mfma_f32_16x16x32_bf16 v[36:39], v[12:15], v[88:91], v[36:39]
    s_waitcnt lgkmcnt(6)
    v_mfma_f32_16x16x32_bf16 v[40:43], v[12:15], v[96:99], v[40:43]
    s_waitcnt lgkmcnt(4)
    v_mfma_f32_16x16x32_bf16 v[44:47], v[12:15], v[104:107], v[44:47]
    s_waitcnt lgkmcnt(2)
    v_mfma_f32_16x16x32_bf16 v[48:51], v[12:15], v[112:115], v[48:51]
    s_waitcnt lgkmcnt(0)
    v_mfma_f32_16x16x32_bf16 v[52:55], v[12:15], v[120:123], v[52:55]
    s_add_u32 s67, s67, 0x20000
    s_and_b32 s67, s67, 0x1e0000
    s_or_b32 s68, s67, s65
    s_add_u32 m0, s66, 4096
    s_waitcnt lgkmcnt(1)
    buffer_load_dwordx4 v5, s[32:35], s68 offen offset:0 nt lds
    buffer_load_dwordx4 v6, s[32:35], s68 offen offset:1024 nt lds
    buffer_load_dwordx4 v5, s[32:35], s68 offen offset:2048 nt lds
    buffer_load_dwordx4 v6, s[32:35], s68 offen offset:3072 nt lds
    ds_read_b128 v[8:11], v16 offset:1280
    s_waitcnt vmcnt(8)
    ds_read_b64_tr_b16 v[64:65], v2 offset:16384
    ds_read_b64_tr_b16 v[66:67], v2 offset:16896
    s_nop 0
    ds_read_b64_tr_b16 v[72:73], v57 offset:16384
    ds_read_b64_tr_b16 v[74:75], v57 offset:16896
    ds_read_b64_tr_b16 v[80:81], v58 offset:16384
    ds_read_b64_tr_b16 v[82:83], v58 offset:16896
    ds_read_b64_tr_b16 v[88:89], v59 offset:16384
    ds_read_b64_tr_b16 v[90:91], v59 offset:16896
    ds_read_b64_tr_b16 v[96:97], v60 offset:16384
    ds_read_b64_tr_b16 v[98:99], v60 offset:16896
    ds_read_b64_tr_b16 v[104:105], v61 offset:16384
    s_waitcnt lgkmcnt(9)
    v_mfma_f32_16x16x32_bf16 v[24:27], v[8:11], v[64:67], v[24:27]
    ds_read_b64_tr_b16 v[106:107], v61 offset:16896
    ds_read_b64_tr_b16 v[112:113], v62 offset:16384
    s_waitcnt lgkmcnt(9)
    v_mfma_f32_16x16x32_bf16 v[28:31], v[8:11], v[72:75], v[28:31]
    ds_read_b64_tr_b16 v[114:115], v62 offset:16896
    ds_read_b64_tr_b16 v[120:121], v63 offset:16384
    s_nop 0
    s_waitcnt lgkmcnt(9)
    v_mfma_f32_16x16x32_bf16 v[32:35], v[8:11], v[80:83], v[32:35]
    ds_read_b64_tr_b16 v[122:123], v63 offset:16896
    s_waitcnt lgkmcnt(8)
    v_mfma_f32_16x16x32_bf16 v[36:39], v[8:11], v[88:91], v[36:39]
    s_waitcnt lgkmcnt(6)
    v_mfma_f32_16x16x32_bf16 v[40:43], v[8:11], v[96:99], v[40:43]
    s_waitcnt lgkmcnt(4)
    v_mfma_f32_16x16x32_bf16 v[44:47], v[8:11], v[104:107], v[44:47]
    s_waitcnt lgkmcnt(2)
    v_mfma_f32_16x16x32_bf16 v[48:51], v[8:11], v[112:115], v[48:51]
    s_waitcnt lgkmcnt(0)
    v_mfma_f32_16x16x32_bf16 v[52:55], v[8:11], v[120:123], v[52:55]
    ds_read_b128 v[12:15], v16 offset:1536
    s_waitcnt vmcnt(3)
    s_add_u32 s68, s86, 0x0
    s_add_u32 m0, s87, 0x0
    s_nop 0
    buffer_load_dwordx4 v18, s[96:99], s68 offen nt lds
    s_waitcnt vmcnt(4)
    s_add_u32 s68, s86, 0x8000
    s_add_u32 m0, s87, 0x400
    s_nop 0
    buffer_load_dwordx4 v19, s[96:99], s68 offen nt lds
    s_waitcnt vmcnt(5)
    s_add_u32 s68, s86, 0x10000
    s_add_u32 m0, s87, 0x800
    s_nop 0
    buffer_load_dwordx4 v18, s[96:99], s68 offen nt lds
    s_waitcnt vmcnt(6)
    s_add_u32 s68, s86, 0x18000
    s_add_u32 m0, s87, 0xc00
    s_nop 0
    buffer_load_dwordx4 v19, s[96:99], s68 offen nt lds
    s_waitcnt vmcnt(4)
    ds_read_b64_tr_b16 v[64:65], v2 offset:0
    ds_read_b64_tr_b16 v[66:67], v2 offset:512
    ds_read_b64_tr_b16 v[72:73], v57 offset:0
    ds_read_b64_tr_b16 v[74:75], v57 offset:512
    ds_read_b64_tr_b16 v[80:81], v58 offset:0
    ds_read_b64_tr_b16 v[82:83], v58 offset:512
    ds_read_b64_tr_b16 v[88:89], v59 offset:0
    ds_read_b64_tr_b16 v[90:91], v59 offset:512
    ds_read_b64_tr_b16 v[96:97], v60 offset:0
    ds_read_b64_tr_b16 v[98:99], v60 offset:512
    ds_read_b64_tr_b16 v[104:105], v61 offset:0
    s_waitcnt lgkmcnt(9)
    v_mfma_f32_16x16x32_bf16 v[24:27], v[12:15], v[64:67], v[24:27]
    ds_read_b64_tr_b16 v[106:107], v61 offset:512
    ds_read_b64_tr_b16 v[112:113], v62 offset:0
    s_waitcnt lgkmcnt(9)
    v_mfma_f32_16x16x32_bf16 v[28:31], v[12:15], v[72:75], v[28:31]
    ds_read_b64_tr_b16 v[114:115], v62 offset:512
    ds_read_b64_tr_b16 v[120:121], v63 offset:0
    s_waitcnt lgkmcnt(9)
    v_mfma_f32_16x16x32_bf16 v[32:35], v[12:15], v[80:83], v[32:35]
    ds_read_b64_tr_b16 v[122:123], v63 offset:512
    v_mul_f32_e64 v8, v7, v24
    s_waitcnt lgkmcnt(8)
    v_mfma_f32_16x16x32_bf16 v[36:39], v[12:15], v[88:91], v[36:39]
    v_mul_f32_e64 v9, v7, v28
    s_waitcnt lgkmcnt(6)
    v_mfma_f32_16x16x32_bf16 v[40:43], v[12:15], v[96:99], v[40:43]
    s_nop 0
    v_mul_f32 v10, v7, v32
    s_waitcnt lgkmcnt(4)
    v_mfma_f32_16x16x32_bf16 v[44:47], v[12:15], v[104:107], v[44:47]
    s_waitcnt lgkmcnt(2)
    v_mfma_f32_16x16x32_bf16 v[48:51], v[12:15], v[112:115], v[48:51]
    s_waitcnt lgkmcnt(0)
    v_mfma_f32_16x16x32_bf16 v[52:55], v[12:15], v[120:123], v[52:55]
    v_mul_f32 v11, v7, v36
    ds_write_b128 v22, v[8:11] offset:0
    v_mul_f32 v16, v7, v40
    s_nop 0
    v_mul_f32 v17, v7, v44
    s_nop 0
    v_mul_f32 v18, v7, v48
    s_nop 0
    v_mul_f32 v19, v7, v52
    ds_write_b128 v22, v[16:19] offset:256
L_tail:
    v_lshrrev_b32 v23, 2, v0
    v_lshlrev_b32 v23, 4, v23
    v_bfe_u32 v6, v0, 1, 1
    v_lshl_add_u32 v23, v6, 8, v23
    v_and_b32 v6, 1, v0
    v_lshl_add_u32 v23, v6, 3, v23
    s_lshl_b32 s3, s60, 11
    s_add_u32 s3, s3, 0x26000
    v_add_u32_e64 v23, s3, v23
    s_waitcnt lgkmcnt(0)
    s_barrier
    ds_read_b64 v[8:9], v23 offset:0
    ds_read_b64 v[10:11], v23 offset:512
    ds_read_b64 v[12:13], v23 offset:1024
    ds_read_b64 v[14:15], v23 offset:1536
    v_lshlrev_b32 v17, 2, v0
    s_mov_b32 m0, s3
    v_bfe_u32 v56, v0, 2, 2
    v_lshlrev_b32 v56, 9, v56
    v_lshrrev_b32 v16, 4, v0
    v_lshl_add_u32 v56, v16, 7, v56
    v_bfe_u32 v16, v0, 2, 2
    v_lshl_add_u32 v56, v16, 5, v56
    v_and_b32 v16, 3, v0
    v_lshl_add_u32 v56, v16, 3, v56
    s_lshl_b32 s100, s60, 5
    v_xor_b32_e64 v56, s100, v56
    v_add_u32 v56, 0x1c000, v56
    s_waitcnt lgkmcnt(2)
    v_pk_add_f32 v[8:9], v[8:9], v[10:11]
    s_waitcnt lgkmcnt(0)
    v_pk_add_f32 v[12:13], v[12:13], v[14:15]
    v_pk_add_f32 v[8:9], v[8:9], v[12:13]
    v_cvt_pk_bf16_f32 v7, v8, v9
    buffer_store_dword v7, v17, s[40:43], s72 offen
    s_cmp_eq_u32 s42, 0
    s_cbranch_scc1 L_slow9
L_slow9_b:
    v_lshrrev_b32 v5, 4, v0
    v_and_b32 v6, 15, v0
    v_xor_b32 v16, v5, v6
    v_lshlrev_b32 v16, 4, v16
    v_lshl_add_u32 v18, v5, 8, v16
    s_and_b32 s100, s60, 1
    s_lshl_b32 s100, s100, 7
    v_xor_b32 v18, s100, v18
    v_xor_b32 v19, 64, v18
    v_lshl_add_u32 v20, v6, 8, v16
    v_add_u32 v20, 0x26000, v20
    v_xor_b32_e64 v21, 64, v20
    v_xor_b32 v22, 128, v20
    v_xor_b32 v23, 192, v20
    v_add_u32 v5, s3, v1
    v_lshlrev_b32 v123, 1, v0
    v_and_b32 v6, 1, v0
    v_cmp_eq_u32 vcc, 0, v6
    v_mov_b32 v6, 0x7fff0000
    s_nop 0
    v_cndmask_b32 v123, v6, v123, vcc
    v_lshrrev_b32 v62, 3, v0
    v_mul_u32_u24 v62, 1024, v62
    v_and_b32 v63, 7, v0
    v_lshl_add_u32 v62, v63, 4, v62
    v_and_b32 v63, 32, v0
    v_xor_b32 v62, v62, v63
    v_xor_b32_e64 v63, 64, v62
    buffer_load_dwordx4 v18, s[36:39], s73 offen offset:0 sc1 lds
    buffer_load_dwordx4 v19, s[36:39], s73 offen offset:1024 sc1 lds
    v_mov_b32 v59, 0x7fff0000
    v_lshl_add_u32 v61, v0, 2, s60
    s_lshl_b32 s100, s61, 17
    s_lshl_b32 s101, s62, 7
    s_add_u32 s100, s100, s101
    s_add_u32 s100, s100, 0xffa80
    v_lshl_add_u32 v60, v61, 7, s100
    v_cmp_gt_u32_e64 vcc, 12, v61
    s_nop 1
    v_cndmask_b32_e64 v59, v59, v60, vcc
    s_lshl_b32 s100, s61, 17
    s_mul_i32 s101, s62, 1408
    s_add_u32 s100, s100, s101
    s_add_u32 s100, s100, 0x9000
    v_lshl_add_u32 v60, v61, 7, s100
    v_cmp_gt_u32 vcc, 11, v61
    s_nop 1
    v_cndmask_b32_e64 v59, v59, v60, vcc
    s_waitcnt vmcnt(3)
    s_barrier
    ds_read_b64_tr_b16 v[24:25], v56 offset:0
    ds_read_b64_tr_b16 v[26:27], v56 offset:2048
    ds_read_b64_tr_b16 v[28:29], v56 offset:4096
    ds_read_b64_tr_b16 v[30:31], v56 offset:6144
    ds_read_b64_tr_b16 v[32:33], v56 offset:8192
    ds_read_b64_tr_b16 v[34:35], v56 offset:10240
    ds_read_b64_tr_b16 v[36:37], v56 offset:12288
    ds_read_b64_tr_b16 v[38:39], v56 offset:14336
    s_branch L_pollA_w
L_pollA:
    buffer_load_dwordx4 v18, s[36:39], s73 offen offset:0 sc1 lds
    buffer_load_dwordx4 v19, s[36:39], s73 offen offset:1024 sc1 lds
    s_add_u32 s94, s94, 1
    s_cmp_lt_u32 s94, 0x40000
    s_cselect_b32 s95, -2, -1
L_pollA_w:
    s_waitcnt vmcnt(1)
    ds_read_b128 v[8:11], v5
    s_waitcnt vmcnt(0)
    ds_read_b128 v[12:15], v5 offset:1024
    s_waitcnt lgkmcnt(1)
    v_max3_u32 v7, v8, v9, v10
    v_max_u32 v7, v7, v11
    s_waitcnt lgkmcnt(0)
    v_max3_u32 v7, v7, v12, v13
    v_max3_u32 v7, v7, v14, v15
    v_cmp_lt_u32_e64 vcc, s95, v7
    s_cbranch_vccnz L_pollA
    s_barrier
    ds_read_b128 v[40:43], v20 offset:0
    ds_read_b128 v[44:47], v20 offset:4096
    ds_read_b128 v[48:51], v21 offset:0
    ds_read_b128 v[52:55], v21 offset:4096
    s_cmp_eq_u32 s69, 1
    s_cbranch_scc0 L_l1b
    s_add_u32 s68, s8, 0x0
    s_add_u32 m0, s9, 0x0
    s_nop 0
    buffer_load_dwordx4 v62, s[56:59], s68 offen nt lds
    s_add_u32 s68, s8, 0x2000
    s_add_u32 m0, s9, 0x400
    s_nop 0
    buffer_load_dwordx4 v63, s[56:59], s68 offen nt lds
    buffer_load_dword v59, v59, s[36:39], 0 offen sc1
L_l1b:
    s_waitcnt lgkmcnt(3)
    s_nop 0
    v_mfma_f32_16x16x32_bf16 v[8:11], v[40:43], v[24:27], 0
    ds_read_b128 v[64:67], v22 offset:0
    s_waitcnt lgkmcnt(3)
    v_mfma_f32_16x16x32_bf16 v[8:11], v[44:47], v[24:27], v[8:11]
    ds_read_b128 v[72:75], v22 offset:4096
    s_waitcnt lgkmcnt(3)
    v_mfma_f32_16x16x32_bf16 v[8:11], v[48:51], v[28:31], v[8:11]
    ds_read_b128 v[80:83], v23 offset:0
    s_waitcnt lgkmcnt(3)
    v_mfma_f32_16x16x32_bf16 v[8:11], v[52:55], v[28:31], v[8:11]
    ds_read_b128 v[88:91], v23 offset:4096
    s_waitcnt lgkmcnt(3)
    v_mfma_f32_16x16x32_bf16 v[8:11], v[64:67], v[32:35], v[8:11]
    s_waitcnt lgkmcnt(2)
    v_mfma_f32_16x16x32_bf16 v[8:11], v[72:75], v[32:35], v[8:11]
    s_waitcnt lgkmcnt(1)
    v_mfma_f32_16x16x32_bf16 v[8:11], v[80:83], v[36:39], v[8:11]
    s_waitcnt lgkmcnt(0)
    v_mfma_f32_16x16x32_bf16 v[8:11], v[88:91], v[36:39], v[8:11]
    s_nop 7
    v_add_f32 v8, v8, v9
    v_add_f32 v10, v10, v11
    v_add_f32 v8, v8, v10
    s_nop 1
    v_mov_b32_dpp v7, v8 quad_perm:[1,1,3,3] row_mask:0xf bank_mask:0xf
    v_cvt_pk_bf16_f32 v7, v8, v7
    buffer_store_dword v7, v123, s[24:27], s74 offen sc1
    buffer_store_dword v7, v123, s[24:27], s23 offen sc1
    s_lshl_b32 s100, s80, 0
    s_lshl_b32 s101, s63, 11
    s_add_u32 s100, s100, s101
    s_add_u32 s100, s100, 0xf000
    buffer_load_dwordx4 v[96:99], v1, s[36:39], s100 offen offset:0 sc1
    buffer_load_dwordx4 v[104:107], v1, s[36:39], s100 offen offset:1024 sc1
    s_cmp_eq_u32 s69, 1
    s_cbranch_scc0 L_l1c
    s_lshl_b32 s100, s80, 0
    s_lshl_b32 s101, s60, 11
    s_add_u32 s100, s100, s101
    s_add_u32 s100, s100, 0x11000
    buffer_load_dwordx4 v[24:27], v1, s[36:39], s100 offen offset:0 sc1
    buffer_load_dwordx4 v[28:31], v1, s[36:39], s100 offen offset:1024 sc1
L_l1c:
    v_bfe_u32 v5, v0, 4, 1
    v_lshlrev_b32 v5, 5, v5
    v_bfe_u32 v7, v0, 3, 1
    v_lshl_add_u32 v5, v7, 6, v5
    s_lshl_b32 s100, s60, 5
    v_xor_b32_e64 v5, s100, v5
    v_add_u32 v5, 0x18000, v5
    v_bfe_u32 v7, v0, 5, 1
    v_lshl_add_u32 v5, v7, 12, v5
    v_bfe_u32 v7, v0, 3, 1
    v_lshl_add_u32 v5, v7, 10, v5
    v_bfe_u32 v7, v0, 4, 1
    v_lshl_add_u32 v5, v7, 9, v5
    v_bfe_u32 v7, v0, 2, 1
    v_lshl_add_u32 v5, v7, 7, v5
    v_bfe_u32 v7, v0, 0, 2
    v_lshl_add_u32 v5, v7, 3, v5
    ds_read_b64_tr_b16 v[8:9], v5 offset:32768
    ds_read_b64_tr_b16 v[10:11], v5 offset:33024
    ds_read_b64_tr_b16 v[12:13], v5 offset:40960
    ds_read_b64_tr_b16 v[14:15], v5 offset:41216
    ds_read_b64_tr_b16 v[16:17], v5 offset:34816
    ds_read_b64_tr_b16 v[18:19], v5 offset:35072
    ds_read_b64_tr_b16 v[20:21], v5 offset:43008
    ds_read_b64_tr_b16 v[22:23], v5 offset:43264
    ds_read_b64_tr_b16 v[32:33], v5 offset:0
    ds_read_b64_tr_b16 v[34:35], v5 offset:256
    ds_read_b64_tr_b16 v[36:37], v5 offset:8192
    ds_read_b64_tr_b16 v[38:39], v5 offset:8448
    ds_read_b64_tr_b16 v[40:41], v5 offset:2048
    ds_read_b64_tr_b16 v[42:43], v5 offset:2304
    ds_read_b64_tr_b16 v[44:45], v5 offset:10240
    ds_read_b64_tr_b16 v[46:47], v5 offset:10496
    v_and_b32 v5, 1, v0
    v_lshlrev_b32 v5, 4, v5
    v_lshlrev_b32 v5, v5, s6
    v_bfe_u32 v6, v0, 1, 2
    v_cmp_eq_u32 vcc, 0, v6
    s_nop 1
    v_cndmask_b32 v52, 0, v5, vcc
    v_cmp_eq_u32 vcc, 1, v6
    s_nop 1
    v_cndmask_b32 v53, 0, v5, vcc
    v_cmp_eq_u32 vcc, 2, v6
    s_nop 1
    v_cndmask_b32 v54, 0, v5, vcc
    v_cmp_eq_u32 vcc, 3, v6
    s_nop 1
    v_cndmask_b32 v55, 0, v5, vcc
    v_lshrrev_b32 v122, 5, v0
    v_lshlrev_b32 v122, 6, v122
    v_bfe_u32 v7, v0, 4, 1
    v_lshl_add_u32 v122, v7, 7, v122
    v_and_b32_e64 v7, 15, v0
    v_lshl_add_u32 v122, v7, 1, v122
    v_and_b32 v7, 1, v0
    v_cmp_eq_u32 vcc, 0, v7
    v_mov_b32 v7, 0x7fff0000
    s_nop 0
    v_cndmask_b32 v122, v7, v122, vcc
    v_lshrrev_b32 v121, 5, v0
    v_lshlrev_b32 v121, 8, v121
    v_bfe_u32 v7, v0, 4, 1
    v_lshl_add_u32 v121, v7, 9, v121
    v_bfe_u32 v7, v0, 3, 1
    v_lshl_add_u32 v121, v7, 7, v121
    v_and_b32 v7, 7, v0
    v_add_u32 v7, s60, v7
    v_cmp_eq_u32 vcc, 0, v7
    v_mov_b32 v7, 0x7fff0000
    s_nop 0
    v_cndmask_b32 v121, v7, v121, vcc
    s_bitcmp1_b32 s15, 0
    s_cselect_b32 s68, 0, -1
    v_lshrrev_b32 v120, 4, v0
    v_lshlrev_b32 v120, 10, v120
    v_and_b32 v7, 15, v0
    v_lshl_add_u32 v120, v7, 1, v120
    v_and_b32 v7, 1, v0
    v_cmp_eq_u32 vcc, s68, v7
    v_mov_b32 v7, 0x7fff0000
    s_nop 0
    v_cndmask_b32 v120, v7, v120, vcc
    v_and_b32 v113, 31, v0
    v_lshlrev_b32 v113, 2, v113
    v_lshrrev_b32 v7, 5, v0
    v_lshl_add_u32 v113, v7, 1, v113
    s_lshl_b32 s100, s60, 7
    s_add_u32 s100, s100, 0x26400
    v_add_u32_e64 v113, s100, v113
    v_and_b32_e64 v114, 1, v0
    v_mul_u32_u24 v114, 0xaaaa, v114
    v_add_u32 v114, 0x4444, v114
    v_bfe_u32 v112, v0, 2, 2
    v_lshlrev_b32_e64 v112, 7, v112
    s_cmp_eq_u32 s60, 0
    s_cbranch_scc0 L_pollB_n
    buffer_load_dwordx4 v[56:59], v1, s[24:27], s75 offen offset:0 sc1
    buffer_load_dwordx4 v[60:63], v1, s[24:27], s75 offen offset:1024 sc1
    buffer_load_dwordx4 v[64:67], v1, s[24:27], s75 offen offset:2048 sc1
    buffer_load_dwordx4 v[72:75], v1, s[24:27], s75 offen offset:3072 sc1
L_pollB_n:
    v_and_b32_e64 v7, 1, v0
    v_lshl_add_u32 v112, v7, 4, v112
    v_lshrrev_b32_e64 v7, 4, v0
    v_lshl_add_u32 v112, v7, 5, v112
    v_add_u32 v112, 0x26400, v112
    v_bfe_u32 v115, v0, 4, 1
    v_lshlrev_b32 v115, 5, v115
    v_bfe_u32 v7, v0, 3, 1
    v_lshl_add_u32 v115, v7, 6, v115
    s_lshl_b32 s100, s60, 5
    v_xor_b32_e64 v115, s100, v115
    v_add_u32 v115, 0x18000, v115
    v_bfe_u32 v7, v0, 5, 1
    v_lshl_add_u32 v115, v7, 11, v115
    v_bfe_u32 v7, v0, 3, 1
    v_lshl_add_u32 v115, v7, 10, v115
    v_bfe_u32 v7, v0, 4, 1
    v_lshl_add_u32 v115, v7, 9, v115
    v_bfe_u32 v7, v0, 2, 1
    v_lshl_add_u32 v115, v7, 7, v115
    v_bfe_u32 v7, v0, 0, 2
    v_lshl_add_u32 v115, v7, 3, v115
    s_lshl_b32 s68, s83, 0
    s_lshl_b32 s101, s60, 8
    s_add_u32 s68, s68, s101
    s_lshl_b32 s3, s83, 0
    s_lshl_b32 s101, s62, 2
    s_add_u32 s3, s3, s101
    s_add_u32 s74, s74, 0x1000
    s_add_u32 s23, s23, 0x1000
    s_waitcnt lgkmcnt(0)
    s_cmp_eq_u32 s60, 0
    s_cbranch_scc0 L_nored1
    s_waitcnt vmcnt(3)
    v_mfma_f32_16x16x32_bf16 v[80:83], v[56:59], v[52:55], 0
    v_max3_u32 v7, v56, v57, v58
    v_max_u32 v7, v7, v59
    s_waitcnt vmcnt(2)
    v_mfma_f32_16x16x32_bf16 v[80:83], v[60:63], v[52:55], v[80:83]
    v_max3_u32 v7, v7, v60, v61
    v_max3_u32 v7, v7, v62, v63
    s_waitcnt vmcnt(1)
    v_mfma_f32_16x16x32_bf16 v[80:83], v[64:67], v[52:55], v[80:83]
    v_max3_u32 v7, v7, v64, v65
    v_max3_u32 v7, v7, v66, v67
    s_waitcnt vmcnt(0)
    v_mfma_f32_16x16x32_bf16 v[80:83], v[72:75], v[52:55], v[80:83]
    v_max3_u32 v7, v7, v72, v73
    v_max3_u32 v7, v7, v74, v75
    v_cmp_lt_u32 vcc, s95, v7
    s_cbranch_vccz L_pollB_d
L_pollB:
    buffer_load_dwordx4 v[56:59], v1, s[24:27], s75 offen offset:0 sc1
    buffer_load_dwordx4 v[60:63], v1, s[24:27], s75 offen offset:1024 sc1
    buffer_load_dwordx4 v[64:67], v1, s[24:27], s75 offen offset:2048 sc1
    buffer_load_dwordx4 v[72:75], v1, s[24:27], s75 offen offset:3072 sc1
    s_add_u32 s94, s94, 1
    s_cmp_lt_u32 s94, 0x40000
    s_cselect_b32 s95, -2, -1
    s_waitcnt vmcnt(7)
    v_max3_u32 v7, v56, v57, v58
    v_max_u32 v7, v7, v59
    v_mfma_f32_16x16x32_bf16 v[80:83], v[56:59], v[52:55], 0
    s_waitcnt vmcnt(6)
    v_max3_u32 v7, v7, v60, v61
    v_max3_u32 v7, v7, v62, v63
    v_mfma_f32_16x16x32_bf16 v[80:83], v[60:63], v[52:55], v[80:83]
    s_waitcnt vmcnt(5)
    v_max3_u32 v7, v7, v64, v65
    v_max3_u32 v7, v7, v66, v67
    v_mfma_f32_16x16x32_bf16 v[80:83], v[64:67], v[52:55], v[80:83]
    s_waitcnt vmcnt(4)
    v_max3_u32 v7, v7, v72, v73
    v_max3_u32 v7, v7, v74, v75
    v_cmp_lt_u32 vcc, s95, v7
    v_mfma_f32_16x16x32_bf16 v[80:83], v[72:75], v[52:55], v[80:83]
    s_cbranch_vccnz L_pollB
    s_nop 2
L_pollB_d:
    s_nop 3
    v_cndmask_b32 v80, v80, v81, s[88:89]
    v_cndmask_b32 v82, v82, v83, s[88:89]
    s_nop 1
    v_permlane32_swap_b32 v80, v82
    v_add_f32 v3, v3, v80
    v_add_f32 v3, v3, v82
    s_nop 1
    v_mov_b32_dpp v7, v3 quad_perm:[1,1,3,3] row_mask:0xf bank_mask:0xf
    v_cvt_pk_bf16_f32 v7, v3, v7
    buffer_store_dword v7, v122, s[40:43], s76 offen
    s_cmp_eq_u32 s42, 0
    s_cbranch_scc1 L_slow10
L_slow10_b:
    v_lshlrev_b32 v3, 16, v7
L_red1:
    s_barrier
    v_mul_f32_e64 v6, v3, v3
    v_add_f32_dpp v5, v3, v3 row_ror:8 row_mask:0xf bank_mask:0xf
    v_add_f32 v24, v24, v25
    v_add_f32_dpp v6, v6, v6 row_ror:8 row_mask:0xf bank_mask:0xf
    v_cndmask_b32 v5, v5, v6, s[88:89]
    v_add_f32 v26, v26, v27
    v_add_f32 v28, v28, v29
    v_add_f32_dpp v5, v5, v5 quad_perm:[1,0,3,2] row_mask:0xf bank_mask:0xf
    buffer_load_dwordx4 v[56:59], v1, s[36:39], s77 offen offset:0 sc1
    v_add_f32 v30, v30, v31
    v_add_f32_e64 v96, v96, v97
    v_add_f32_dpp v5, v5, v5 quad_perm:[2,3,0,1] row_mask:0xf bank_mask:0xf
    v_add_f32 v98, v98, v99
    v_add_f32 v104, v104, v105
    v_add_f32_dpp v5, v5, v5 row_half_mirror row_mask:0xf bank_mask:0xf
    buffer_store_dword v5, v121, s[40:43], s3 offen
    s_cmp_eq_u32 s42, 0
    s_cbranch_scc1 L_slow11
L_slow11_b:
    v_add_f32 v106, v106, v107
    v_add_f32 v24, v24, v26
    v_add_f32 v28, v28, v30
    v_add_f32 v96, v96, v98
    v_add_f32_e64 v104, v104, v106
    v_mul_f32 v50, 0xbb000000, v24
    v_mul_f32 v51, 0xbb000000, v28
    buffer_load_dwordx4 v[56:59], v1, s[36:39], s77 offen offset:0 sc1
    v_mul_f32 v48, 0xbb000000, v96
    v_mul_f32 v49, 0xbb000000, v104
    v_mov_b64 v[80:81], 0
    v_mov_b64 v[90:91], 0
    ds_read_b64_tr_b16 v[24:25], v115 offset:49152
    ds_read_b64_tr_b16 v[26:27], v115 offset:49408
    ds_read_b64_tr_b16 v[28:29], v115 offset:53248
    ds_read_b64_tr_b16 v[30:31], v115 offset:53504
    v_lshlrev_b32 v115, 2, v0
    s_branch L_pollXB_w
L_pollXB:
    buffer_load_dwordx4 v[56:59], v1, s[36:39], s77 offen offset:0 sc1
    s_add_u32 s94, s94, 1
    s_cmp_lt_u32 s94, 0x40000
    s_cselect_b32 s95, -2, -1
    s_nop 1
    v_mov_b64 v[80:81], 0
    v_mov_b64 v[90:91], 0
L_pollXB_w:
    s_waitcnt vmcnt(2)
    v_max3_u32 v7, v56, v57, v58
    v_max_u32_e64 v7, v7, v59
    v_cmp_lt_u32_e64 vcc, s95, v7
    v_smfmac_f32_16x16x64_bf16 v[80:83], v[56:59], v[8:15], v114
    v_smfmac_f32_16x16x64_bf16 v[88:91], v[56:59], v[16:23], v114
    s_cbranch_vccnz L_pollXB
L_pollXB_d:
    buffer_load_dword v60, v115, s[36:39], s68 offen offset:0 sc1
    s_nop 4
    v_add_f32_e64 v80, v80, v81
    v_add_f32 v90, v90, v91
    v_add_f32_e64 v80, v80, v90
    s_nop 1
    v_mov_b32_dpp v6, v80 quad_perm:[1,1,3,3] row_mask:0xf bank_mask:0xf
    v_cvt_pk_bf16_f32 v6, v80, v6
    buffer_store_dword v6, v120, s[40:43], s78 offen
    s_cmp_eq_u32 s42, 0
    s_cbranch_scc1 L_slow12
L_slow12_b:
    v_mov_b32 v5, 0
    s_bitcmp1_b32 s15, 1
    s_cbranch_scc0 L_nod
    s_branch L_pollCs_c
L_pollCs_r:
    buffer_load_dword v60, v115, s[36:39], s68 offen offset:0 sc1
    s_add_u32 s94, s94, 1
    s_cmp_lt_u32 s94, 0x40000
    s_cselect_b32 s95, -2, -1
    s_waitcnt vmcnt(0)
L_pollCs_c:
    s_waitcnt vmcnt(1)
    v_cmp_lt_u32_e64 vcc, s95, v60
    v_add_f32_dpp v80, v60, v60 row_ror:1 row_mask:0xf bank_mask:0xf
    s_nop 1
    v_add_f32_dpp v80, v80, v80 row_ror:2 row_mask:0xf bank_mask:0xf
    s_cbranch_vccnz L_pollCs_r
    buffer_load_dword v56, v115, s[36:39], s79 offen offset:0 sc1
    buffer_load_dword v57, v115, s[36:39], s79 offen offset:256 sc1
    buffer_load_dword v58, v115, s[36:39], s79 offen offset:512 sc1
    buffer_load_dword v59, v115, s[36:39], s79 offen offset:768 sc1
    v_add_f32_dpp v80, v80, v80 row_ror:4 row_mask:0xf bank_mask:0xf
    s_nop 1
    v_add_f32_dpp v80, v80, v80 row_ror:8 row_mask:0xf bank_mask:0xf
    s_nop 1
    v_add_f32_dpp v80, v80, v80 row_bcast:15 row_mask:0xa bank_mask:0xf
    s_nop 0
    v_readlane_b32 s81, v80, 31
    v_mul_f32 v80, 0x3b000000, v80
    s_nop 0
    v_mov_b32_e64 v81, s81
    v_mul_f32 v81, 0x3b000000, v81
    v_fma_f32 v80, -v81, v81, v80
    v_max_f32 v80, 0, v80
    v_add_f32 v80, 0x3727c5ac, v80
    v_rcp_f32 v80, v80
    buffer_load_dword v56, v115, s[36:39], s79 offen offset:0 sc1
    buffer_load_dword v57, v115, s[36:39], s79 offen offset:256 sc1
    buffer_load_dword v58, v115, s[36:39], s79 offen offset:512 sc1
    buffer_load_dword v59, v115, s[36:39], s79 offen offset:768 sc1
    s_nop 0
    v_readlane_b32 s82, v80, 63
    v_mul_f32_e64 v82, s81, v48
    v_mul_f32_e64 v83, s81, v49
    s_branch L_pollC_w
L_pollC:
    buffer_load_dword v56, v115, s[36:39], s79 offen offset:0 sc1
    buffer_load_dword v57, v115, s[36:39], s79 offen offset:256 sc1
    buffer_load_dword v58, v115, s[36:39], s79 offen offset:512 sc1
    buffer_load_dword v59, v115, s[36:39], s79 offen offset:768 sc1
    s_add_u32 s94, s94, 1
    s_cmp_lt_u32 s94, 0x40000
    s_cselect_b32 s95, -2, -1
L_pollC_w:
    s_waitcnt vmcnt(4)
    v_max3_u32 v7, v56, v57, v58
    v_max_u32 v7, v7, v59
    v_cmp_lt_u32_e64 vcc, s95, v7
    v_dot2_f32_bf16 v80, v56, s6, v82
    v_dot2_f32_bf16 v81, v56, s7, v83
    v_dot2_f32_bf16 v80, v57, s6, v80
    v_dot2_f32_bf16 v81, v57, s7, v81
    v_dot2_f32_bf16 v80, v58, s6, v80
    v_dot2_f32_bf16 v81, v58, s7, v81
    v_dot2_f32_bf16 v80, v59, s6, v80
    v_dot2_f32_bf16 v81, v59, s7, v81
    s_cbranch_vccnz L_pollC
L_pollC_d:
    s_nop 1
    v_permlane32_swap_b32 v80, v81
    v_mul_f32 v80, s82, v80
    v_mul_f32_e64 v80, v80, v81
    v_cvt_pk_bf16_f32 v80, v80, v80
    ds_write_b16 v113, v80
    v_mov_b64_e64 v[88:89], 0
    s_waitcnt lgkmcnt(0)
    s_barrier
    ds_read_b128 v[60:63], v112
    s_waitcnt lgkmcnt(0)
    v_smfmac_f32_16x16x64_bf16 v[88:91], v[60:63], v[24:31], v114
    s_nop 7
    v_add_f32 v7, v88, v89
    s_nop 1
    v_mov_b32_dpp v5, v7 quad_perm:[1,1,3,3] row_mask:0xf bank_mask:0xf
    v_cvt_pk_bf16_f32 v5, v7, v5
L_nod:
    buffer_store_dword v5, v123, s[24:27], s74 offen sc1
    buffer_store_dword v5, v123, s[24:27], s23 offen sc1
    s_add_u32 s68, s75, 0x1000
    s_cmp_eq_u32 s69, 1
    s_cbranch_scc0 L_last
    s_waitcnt vmcnt(2) lgkmcnt(0)
    v_mov_b32 v28, v122
    v_mov_b32_e64 v30, v121
    s_add_u32 s74, s74, 0x3000
    s_add_u32 s23, s23, 0x3000
    s_add_u32 s75, s75, 0x4000
    v_xor_b32 v57, 32, v2
    v_xor_b32 v58, 64, v2
    v_xor_b32 v59, 96, v2
    v_xor_b32 v60, 128, v2
    v_xor_b32 v61, 160, v2
    v_xor_b32 v62, 192, v2
    v_xor_b32 v63, 224, v2
    v_and_b32 v56, 1, v0
    v_mul_u32_u24 v56, 0xaaaa, v56
    v_add_u32 v56, 0x4444, v56
    v_mov_b64 v[64:65], 0
    v_mov_b64 v[66:67], 0
    v_mov_b64 v[72:73], 0
    v_mov_b64 v[74:75], 0
    v_mov_b64 v[80:81], 0
    v_mov_b64 v[82:83], 0
    v_mov_b64 v[88:89], 0
    v_mov_b64 v[90:91], 0
    v_mov_b64 v[96:97], 0
    v_mov_b64 v[98:99], 0
    v_mov_b64 v[104:105], 0
    v_mov_b64 v[106:107], 0
    v_mov_b64 v[112:113], 0
    v_mov_b64 v[114:115], 0
    v_mov_b64 v[120:121], 0
    v_mov_b64 v[122:123], 0
    v_lshrrev_b32 v29, 4, v0
    v_lshlrev_b32 v29, 12, v29
    v_and_b32 v7, 15, v0
    v_lshl_add_u32 v29, v7, 1, v29
    v_and_b32 v7, 1, v0
    v_cmp_eq_u32 vcc, 0, v7
    v_mov_b32 v7, 0x7fff0000
    s_nop 0
    v_cndmask_b32 v29, v7, v29, vcc
    v_lshrrev_b32 v31, 3, v0
    v_lshlrev_b32 v31, 5, v31
    v_and_b32_e64 v7, 1, v0
    v_lshl_add_u32 v31, v7, 4, v31
    v_bfe_u32 v7, v0, 1, 2
    v_lshl_add_u32 v31, v7, 2, v31
    s_mul_i32 s100, s60, 2112
    s_add_u32 s100, s100, 0x26600
    v_add_u32 v31, s100, v31
    v_lshrrev_b32 v48, 4, v0
    v_lshlrev_b32 v48, 5, v48
    v_and_b32 v7, 1, v0
    v_lshl_add_u32 v48, v7, 4, v48
    v_bfe_u32 v7, v0, 2, 2
    v_mul_u32_u24 v7, 2112, v7
    v_add_u32 v48, v48, v7
    v_add_u32 v48, 0x26600, v48
    v_mov_b32 v49, v48
    v_and_b32 v7, 2, v0
    v_cmp_eq_u32 vcc, 0, v7
    v_mov_b32 v7, 0x30000
    s_nop 0
    v_cndmask_b32 v48, v7, v48, vcc
    v_and_b32 v7, 2, v0
    v_cmp_eq_u32 vcc, 2, v7
    v_mov_b32 v7, 0x30000
    s_nop 0
    v_cndmask_b32 v49, v7, v49, vcc
    v_bfe_u32 v5, v0, 2, 2
    v_lshlrev_b32 v5, 6, v5
    v_lshrrev_b32 v7, 5, v0
    v_lshl_add_u32 v5, v7, 8, v5
    v_bfe_u32 v7, v0, 4, 1
    v_lshl_add_u32 v5, v7, 5, v5
    v_and_b32_e64 v7, 1, v0
    v_lshl_add_u32 v5, v7, 4, v5
    s_mul_i32 s100, s60, 2112
    s_add_u32 s100, s100, 0x18000
    v_add_u32 v5, s100, v5
    v_and_b32 v7, 2, v0
    v_cmp_eq_u32_e64 vcc, 0, v7
    v_mov_b32 v7, 0x30000
    s_nop 0
    v_cndmask_b32 v5, v7, v5, vcc
    v_mov_b32 v6, v1
    v_and_b32 v7, 15, v0
    v_cmp_eq_u32_e64 vcc, 0, v7
    v_mov_b32 v7, 0x7fff0000
    s_cmp_eq_u32 s60, 0
    s_cbranch_scc0 L_pollD_n
    buffer_load_dwordx4 v[8:11], v1, s[24:27], s68 offen offset:0 sc1
    buffer_load_dwordx4 v[12:15], v1, s[24:27], s68 offen offset:1024 sc1
    buffer_load_dwordx4 v[16:19], v1, s[24:27], s68 offen offset:2048 sc1
    buffer_load_dwordx4 v[20:23], v1, s[24:27], s68 offen offset:3072 sc1
L_pollD_n:
    v_cndmask_b32 v6, v7, v6, vcc
    s_lshl_b32 s98, s83, 0
    s_lshl_b32 s101, s63, 8
    s_add_u32 s98, s98, s101
    s_add_u32 s98, s98, 0x400
    s_lshl_b32 s87, s83, 0
    s_lshl_b32 s101, s62, 2
    s_add_u32 s87, s87, s101
    s_add_u32 s87, s87, 0x400
    s_lshl_b32 s86, s61, 17
    s_lshl_b32 s101, s62, 11
    s_add_u32 s86, s86, s101
    s_lshl_b32 s101, s60, 9
    s_add_u32 s86, s86, s101
    s_add_u32 s3, s76, 0x2000
    s_add_u32 s99, s77, 0x2000
    s_waitcnt lgkmcnt(0)
    s_cmp_eq_u32 s60, 0
    s_cbranch_scc0 L_fill3
L_redd:
    s_waitcnt vmcnt(3)
    v_mfma_f32_16x16x32_bf16 v[24:27], v[8:11], v[52:55], 0
    v_max3_u32 v7, v8, v9, v10
    v_max_u32 v7, v7, v11
    s_waitcnt vmcnt(2)
    v_mfma_f32_16x16x32_bf16 v[24:27], v[12:15], v[52:55], v[24:27]
    v_max3_u32 v7, v7, v12, v13
    v_max3_u32 v7, v7, v14, v15
    s_waitcnt vmcnt(1)
    v_mfma_f32_16x16x32_bf16 v[24:27], v[16:19], v[52:55], v[24:27]
    v_max3_u32 v7, v7, v16, v17
    v_max3_u32 v7, v7, v18, v19
    s_waitcnt vmcnt(0)
    v_mfma_f32_16x16x32_bf16 v[24:27], v[20:23], v[52:55], v[24:27]
    v_max3_u32 v7, v7, v20, v21
    v_max3_u32 v7, v7, v22, v23
    v_cmp_lt_u32 vcc, s95, v7
    s_cbranch_vccz L_pollD_d
L_pollD:
    buffer_load_dwordx4 v[8:11], v1, s[24:27], s68 offen offset:0 sc1
    buffer_load_dwordx4 v[12:15], v1, s[24:27], s68 offen offset:1024 sc1
    buffer_load_dwordx4 v[16:19], v1, s[24:27], s68 offen offset:2048 sc1
    buffer_load_dwordx4 v[20:23], v1, s[24:27], s68 offen offset:3072 sc1
    s_add_u32 s94, s94, 1
    s_cmp_lt_u32 s94, 0x40000
    s_cselect_b32 s95, -2, -1
    s_waitcnt vmcnt(7)
    v_max3_u32 v7, v8, v9, v10
    v_max_u32 v7, v7, v11
    v_mfma_f32_16x16x32_bf16 v[24:27], v[8:11], v[52:55], 0
    s_waitcnt vmcnt(6)
    v_max3_u32 v7, v7, v12, v13
    v_max3_u32 v7, v7, v14, v15
    v_mfma_f32_16x16x32_bf16 v[24:27], v[12:15], v[52:55], v[24:27]
    s_waitcnt vmcnt(5)
    v_max3_u32 v7, v7, v16, v17
    v_max3_u32 v7, v7, v18, v19
    v_mfma_f32_16x16x32_bf16 v[24:27], v[16:19], v[52:55], v[24:27]
    s_waitcnt vmcnt(4)
    v_max3_u32 v7, v7, v20, v21
    v_max3_u32 v7, v7, v22, v23
    v_cmp_lt_u32 vcc, s95, v7
    v_mfma_f32_16x16x32_bf16 v[24:27], v[20:23], v[52:55], v[24:27]
    s_cbranch_vccnz L_pollD
    s_nop 2
L_pollD_d:
    s_nop 3
    v_cndmask_b32 v24, v24, v25, s[88:89]
    v_cndmask_b32 v26, v26, v27, s[88:89]
    s_nop 1
    v_permlane32_swap_b32 v24, v26
    v_add_f32 v3, v3, v24
    v_add_f32 v3, v3, v26
    s_nop 1
    v_mov_b32_dpp v7, v3 quad_perm:[1,1,3,3] row_mask:0xf bank_mask:0xf
    v_cvt_pk_bf16_f32 v7, v3, v7
    buffer_store_dword v7, v28, s[40:43], s3 offen
    s_cmp_eq_u32 s42, 0
    s_cbranch_scc1 L_slow13
L_slow13_b:
    s_cmp_eq_u32 s69, 2
    s_cbranch_scc1 L_out
    v_lshlrev_b32 v3, 16, v7
L_nored2:
    s_barrier
    v_mul_f32_e64 v27, v3, v3
    v_add_f32_dpp v26, v3, v3 row_ror:8 row_mask:0xf bank_mask:0xf
    buffer_load_dwordx4 v[52:55], v1, s[36:39], s99 offen offset:0 sc1
    v_add_f32_dpp v27, v27, v27 row_ror:8 row_mask:0xf bank_mask:0xf
    v_cndmask_b32 v26, v26, v27, s[88:89]
    s_nop 1
    v_add_f32_dpp v26, v26, v26 quad_perm:[1,0,3,2] row_mask:0xf bank_mask:0xf
    s_nop 1
    v_add_f32_dpp v26, v26, v26 quad_perm:[2,3,0,1] row_mask:0xf bank_mask:0xf
    s_nop 1
    v_add_f32_dpp v26, v26, v26 row_half_mirror row_mask:0xf bank_mask:0xf
    buffer_store_dword v26, v30, s[40:43], s87 offen
    s_cmp_eq_u32 s42, 0
    s_cbranch_scc1 L_slow14
L_slow14_b:
    v_lshlrev_b32 v28, 2, v0
    buffer_load_dwordx4 v[52:55], v1, s[36:39], s99 offen offset:0 sc1
    s_waitcnt vmcnt(4)
    v_mov_b64 v[8:9], 0
    v_mov_b64 v[14:15], 0
    s_branch L_pollXD_w
L_pollXD:
    buffer_load_dwordx4 v[52:55], v1, s[36:39], s99 offen offset:0 sc1
    s_add_u32 s94, s94, 1
    s_cmp_lt_u32 s94, 0x40000
    s_cselect_b32 s95, -2, -1
    s_nop 1
    v_mov_b64 v[8:9], 0
    v_mov_b64 v[14:15], 0
L_pollXD_w:
    s_waitcnt vmcnt(2)
    v_max3_u32 v7, v52, v53, v54
    v_max_u32 v7, v7, v55
    v_cmp_lt_u32 vcc, s95, v7
    v_smfmac_f32_16x16x64_bf16 v[8:11], v[52:55], v[32:39], v56
    v_smfmac_f32_16x16x64_bf16 v[12:15], v[52:55], v[40:47], v56
    s_cbranch_vccnz L_pollXD
L_pollXD_d:
    buffer_load_dword v24, v28, s[36:39], s98 offen offset:0 sc1
    s_nop 4
    v_add_f32 v8, v8, v9
    v_add_f32 v14, v14, v15
    v_add_f32 v8, v8, v14
    s_nop 1
    v_mov_b32_dpp v10, v8 quad_perm:[1,1,3,3] row_mask:0xf bank_mask:0xf
    v_cvt_pk_bf16_f32 v10, v8, v10
    buffer_store_dword v10, v29, s[40:43], s84 offen
    s_cmp_eq_u32 s42, 0
    s_cbranch_scc1 L_slow15
L_slow15_b:
    s_branch L_pollEs_c
L_pollEs_r:
    buffer_load_dword v24, v28, s[36:39], s98 offen offset:0 sc1
    s_add_u32 s94, s94, 1
    s_cmp_lt_u32 s94, 0x40000
    s_cselect_b32 s95, -2, -1
    s_waitcnt vmcnt(0)
L_pollEs_c:
    s_waitcnt vmcnt(1)
    v_cmp_lt_u32 vcc, s95, v24
    v_add_f32_dpp v32, v24, v24 row_ror:1 row_mask:0xf bank_mask:0xf
    s_nop 1
    v_add_f32_dpp v32, v32, v32 row_ror:2 row_mask:0xf bank_mask:0xf
    s_cbranch_vccnz L_pollEs_r
    buffer_load_dword v52, v28, s[36:39], s85 offen offset:0 sc1
    buffer_load_dword v53, v28, s[36:39], s85 offen offset:256 sc1
    buffer_load_dword v54, v28, s[36:39], s85 offen offset:512 sc1
    buffer_load_dword v55, v28, s[36:39], s85 offen offset:768 sc1
    v_add_f32_dpp v32, v32, v32 row_ror:4 row_mask:0xf bank_mask:0xf
    s_nop 1
    v_add_f32_dpp v32, v32, v32 row_ror:8 row_mask:0xf bank_mask:0xf
    s_nop 1
    v_add_f32_dpp v32, v32, v32 row_bcast:15 row_mask:0xa bank_mask:0xf
    s_nop 0
    v_readlane_b32 s81, v32, 31
    v_mul_f32 v32, 0x3b000000, v32
    s_nop 0
    v_mov_b32_e64 v33, s81
    v_mul_f32 v33, 0x3b000000, v33
    v_fma_f32 v32, -v33, v33, v32
    v_max_f32 v32, 0, v32
    v_add_f32 v32, 0x3727c5ac, v32
    v_rsq_f32 v32, v32
    buffer_load_dword v52, v28, s[36:39], s85 offen offset:0 sc1
    buffer_load_dword v53, v28, s[36:39], s85 offen offset:256 sc1
    buffer_load_dword v54, v28, s[36:39], s85 offen offset:512 sc1
    buffer_load_dword v55, v28, s[36:39], s85 offen offset:768 sc1
    v_mul_f32 v32, 0x3e0293ee, v32
    s_nop 0
    v_readlane_b32 s82, v32, 63
    v_mul_f32 v34, s81, v50
    v_mul_f32 v35, s81, v51
    s_branch L_pollE_w
L_pollE:
    buffer_load_dword v52, v28, s[36:39], s85 offen offset:0 sc1
    buffer_load_dword v53, v28, s[36:39], s85 offen offset:256 sc1
    buffer_load_dword v54, v28, s[36:39], s85 offen offset:512 sc1
    buffer_load_dword v55, v28, s[36:39], s85 offen offset:768 sc1
    s_add_u32 s94, s94, 1
    s_cmp_lt_u32 s94, 0x40000
    s_cselect_b32 s95, -2, -1
L_pollE_w:
    s_waitcnt vmcnt(4)
    v_max3_u32 v7, v52, v53, v54
    v_max_u32 v7, v7, v55
    v_cmp_lt_u32_e64 vcc, s95, v7
    v_dot2_f32_bf16 v32, v52, s6, v34
    v_dot2_f32_bf16 v33, v52, s7, v35
    v_dot2_f32_bf16 v32, v53, s6, v32
    v_dot2_f32_bf16 v33, v53, s7, v33
    v_dot2_f32_bf16 v32, v54, s6, v32
    v_dot2_f32_bf16 v33, v54, s7, v33
    v_dot2_f32_bf16 v32, v55, s6, v32
    v_dot2_f32_bf16 v33, v55, s7, v33
    s_cbranch_vccnz L_pollE
L_pollE_d:
    s_nop 1
    v_cvt_pk_bf16_f32 v32, v32, v33
    ds_write_b32 v31, v32
    s_add_u32 s36, s36, 0x100000
    s_addc_u32 s37, s37, 0
    s_add_u32 s40, s40, 0x100000
    s_addc_u32 s41, s41, 0
    s_add_u32 s44, s44, 0x100000
    s_addc_u32 s45, s45, 0
    s_sub_u32 s80, s80, 0x100000
    s_mov_b32 s69, 2
    v_min_u32 v38, 3, v0
    v_lshlrev_b32 v38, 7, v38
    s_waitcnt lgkmcnt(0)
    s_barrier
    ds_read_b128 v[8:11], v48 offset:0
    ds_read_b128 v[12:15], v48 offset:128
    ds_read_b128 v[16:19], v49 offset:0
    ds_read_b128 v[20:23], v49 offset:128
    buffer_load_dword v38, v38, s[36:39], s86 offen offset:0 sc1
    v_mov_b64 v[24:25], 0
    v_mov_b64 v[28:29], 0
    v_mov_b64 v[32:33], 0
    v_mov_b64 v[36:37], 0
    v_mov_b64 v[40:41], 0
    v_mov_b64 v[44:45], 0
    v_mov_b64 v[48:49], 0
    s_waitcnt lgkmcnt(3)
    v_smfmac_f32_16x16x64_bf16 v[64:67], v[8:11], a[0:7], v56
    s_mov_b32 s100, 0x3f803f80
    s_lshl_b32 s4, s60, 9
    s_add_u32 s4, s4, 0x26000
    s_waitcnt lgkmcnt(2)
    v_smfmac_f32_16x16x64_bf16 v[64:67], v[12:15], a[8:15], v56
    ds_read_b64_tr_b16 a[0:1], v2 offset:8192
    ds_read_b64_tr_b16 a[2:3], v2 offset:8704
    s_waitcnt lgkmcnt(3)
    v_smfmac_f32_16x16x64_bf16 v[64:67], v[16:19], a[16:23], v56
    ds_read_b64_tr_b16 a[8:9], v57 offset:8192
    ds_read_b64_tr_b16 a[10:11], v57 offset:8704
    s_waitcnt lgkmcnt(4)
    v_smfmac_f32_16x16x64_bf16 v[64:67], v[20:23], a[24:31], v56
    ds_read_b64_tr_b16 a[16:17], v58 offset:8192
    ds_read_b64_tr_b16 a[18:19], v58 offset:8704
    v_smfmac_f32_16x16x64_bf16 v[72:75], v[8:11], a[32:39], v56
    ds_read_b64_tr_b16 a[24:25], v59 offset:8192
    ds_read_b64_tr_b16 a[26:27], v59 offset:8704
    v_smfmac_f32_16x16x64_bf16 v[72:75], v[12:15], a[40:47], v56
    ds_read_b64_tr_b16 a[32:33], v60 offset:8192
    s_nop 0
    v_add_f32 v64, v64, v65
    v_smfmac_f32_16x16x64_bf16 v[72:75], v[16:19], a[48:55], v56
    ds_read_b64_tr_b16 a[34:35], v60 offset:8704
    v_add_f32_e64 v65, v66, v67
    v_smfmac_f32_16x16x64_bf16 v[72:75], v[20:23], a[56:63], v56
    ds_read_b64_tr_b16 a[40:41], v61 offset:8192
    v_max_f32_e64 v7, v64, v65
    v_smfmac_f32_16x16x64_bf16 v[80:83], v[8:11], a[64:71], v56
    ds_read_b64_tr_b16 a[42:43], v61 offset:8704
    v_smfmac_f32_16x16x64_bf16 v[80:83], v[12:15], a[72:79], v56
    ds_read_b64_tr_b16 a[48:49], v62 offset:8192
    ds_read_b64_tr_b16 a[50:51], v62 offset:8704
    v_smfmac_f32_16x16x64_bf16 v[80:83], v[16:19], a[80:87], v56
    ds_read_b64_tr_b16 a[56:57], v63 offset:8192
    v_add_f32_e64 v72, v72, v73
    v_smfmac_f32_16x16x64_bf16 v[80:83], v[20:23], a[88:95], v56
    ds_read_b64_tr_b16 a[58:59], v63 offset:8704
    v_add_f32_e64 v73, v74, v75
    v_smfmac_f32_16x16x64_bf16 v[88:91], v[8:11], a[96:103], v56
    ds_read_b64_tr_b16 a[4:5], v2 offset:16384
    v_max3_f32 v7, v7, v72, v73
    v_smfmac_f32_16x16x64_bf16 v[88:91], v[12:15], a[104:111], v56
    ds_read_b64_tr_b16 a[6:7], v2 offset:16896
    v_smfmac_f32_16x16x64_bf16 v[88:91], v[16:19], a[112:119], v56
    ds_read_b64_tr_b16 a[12:13], v57 offset:16384
    v_add_f32 v80, v80, v81
    v_smfmac_f32_16x16x64_bf16 v[88:91], v[20:23], a[120:127], v56
    ds_read_b64_tr_b16 a[14:15], v57 offset:16896
    v_add_f32 v81, v82, v83
    v_smfmac_f32_16x16x64_bf16 v[96:99], v[8:11], a[160:167], v56
    ds_read_b64_tr_b16 a[20:21], v58 offset:16384
    v_max3_f32 v7, v7, v80, v81
    v_smfmac_f32_16x16x64_bf16 v[96:99], v[12:15], a[168:175], v56
    ds_read_b64_tr_b16 a[22:23], v58 offset:16896
    v_smfmac_f32_16x16x64_bf16 v[96:99], v[16:19], a[176:183], v56
    ds_read_b64_tr_b16 a[28:29], v59 offset:16384
    v_add_f32_e64 v88, v88, v89
    v_smfmac_f32_16x16x64_bf16 v[96:99], v[20:23], a[184:191], v56
    ds_read_b64_tr_b16 a[30:31], v59 offset:16896
    v_add_f32_e64 v89, v90, v91
    v_smfmac_f32_16x16x64_bf16 v[104:107], v[8:11], a[192:199], v56
    ds_read_b64_tr_b16 a[36:37], v60 offset:16384
    v_max3_f32 v7, v7, v88, v89
    v_smfmac_f32_16x16x64_bf16 v[104:107], v[12:15], a[200:207], v56
    ds_read_b64_tr_b16 a[38:39], v60 offset:16896
    v_smfmac_f32_16x16x64_bf16 v[104:107], v[16:19], a[208:215], v56
    ds_read_b64_tr_b16 a[44:45], v61 offset:16384
    v_add_f32_e64 v96, v96, v97
    v_smfmac_f32_16x16x64_bf16 v[104:107], v[20:23], a[216:223], v56
    ds_read_b64_tr_b16 a[46:47], v61 offset:16896
    v_add_f32_e64 v97, v98, v99
    v_smfmac_f32_16x16x64_bf16 v[112:115], v[8:11], a[224:231], v56
    ds_read_b64_tr_b16 a[52:53], v62 offset:16384
    v_max3_f32 v7, v7, v96, v97
    v_smfmac_f32_16x16x64_bf16 v[112:115], v[12:15], a[232:239], v56
    ds_read_b64_tr_b16 a[54:55], v62 offset:16896
    v_smfmac_f32_16x16x64_bf16 v[112:115], v[16:19], a[240:247], v56
    ds_read_b64_tr_b16 a[60:61], v63 offset:16384
    v_add_f32 v104, v104, v105
    v_smfmac_f32_16x16x64_bf16 v[112:115], v[20:23], a[248:255], v56
    s_waitcnt vmcnt(1)
    ds_read_b64_tr_b16 a[62:63], v63 offset:16896
    v_add_f32 v105, v106, v107
    v_smfmac_f32_16x16x64_bf16 v[120:123], v[8:11], a[128:135], v56
    v_max3_f32 v7, v7, v104, v105
    v_smfmac_f32_16x16x64_bf16 v[120:123], v[12:15], a[136:143], v56
    s_nop 1
    v_add_f32 v112, v112, v113
    v_smfmac_f32_16x16x64_bf16 v[120:123], v[16:19], a[144:151], v56
    v_add_f32 v113, v114, v115
    v_smfmac_f32_16x16x64_bf16 v[120:123], v[20:23], a[152:159], v56
    v_max3_f32 v7, v7, v112, v113
    v_subrev_u32 v23, 0xe600, v31
    v_mov_b64 v[52:53], 0
    v_and_b32 v22, 48, v0
    v_mul_u32_u24 v22, 112, v22
    v_add3_u32 v22, v22, v1, s4
    s_nop 1
    v_add_f32_e64 v120, v120, v121
    v_add_f32_e64 v121, v122, v123
    v_max3_f32 v7, v7, v120, v121
    s_nop 1
    v_max_f32_dpp v7, v7, v7 row_ror:1 row_mask:0xf bank_mask:0xf
    s_nop 1
    v_max_f32_dpp v7, v7, v7 row_ror:2 row_mask:0xf bank_mask:0xf
    s_nop 1
    v_max_f32_dpp v7, v7, v7 row_ror:4 row_mask:0xf bank_mask:0xf
    s_nop 1
    v_max_f32_dpp v7, v7, v7 row_ror:8 row_mask:0xf bank_mask:0xf
    v_mul_f32 v20, s82, v7
    v_pk_fma_f32 v[64:65], v[64:65], s[82:83], v[20:21] op_sel_hi:[1,0,0] neg_lo:[0,0,1] neg_hi:[0,0,1]
    v_pk_fma_f32 v[72:73], v[72:73], s[82:83], v[20:21] op_sel_hi:[1,0,0] neg_lo:[0,0,1] neg_hi:[0,0,1]
    v_exp_f32 v64, v64
    v_exp_f32 v65, v65
    v_pk_fma_f32 v[80:81], v[80:81], s[82:83], v[20:21] op_sel_hi:[1,0,0] neg_lo:[0,0,1] neg_hi:[0,0,1]
    v_exp_f32 v72, v72
    v_exp_f32 v73, v73
    v_pk_fma_f32 v[88:89], v[88:89], s[82:83], v[20:21] op_sel_hi:[1,0,0] neg_lo:[0,0,1] neg_hi:[0,0,1]
    v_pk_fma_f32 v[96:97], v[96:97], s[82:83], v[20:21] op_sel_hi:[1,0,0] neg_lo:[0,0,1] neg_hi:[0,0,1]
    v_pk_fma_f32 v[104:105], v[104:105], s[82:83], v[20:21] op_sel_hi:[1,0,0] neg_lo:[0,0,1] neg_hi:[0,0,1]
    v_pk_fma_f32 v[112:113], v[112:113], s[82:83], v[20:21] op_sel_hi:[1,0,0] neg_lo:[0,0,1] neg_hi:[0,0,1]
    v_pk_fma_f32 v[120:121], v[120:121], s[82:83], v[20:21] op_sel_hi:[1,0,0] neg_lo:[0,0,1] neg_hi:[0,0,1]
    v_cvt_pk_bf16_f32 v66, v64, v65
    v_exp_f32 v80, v80
    v_exp_f32 v81, v81
    v_cvt_pk_bf16_f32 v74, v72, v73
    ds_write2st64_b32 v23, v66, v74 offset0:0 offset1:1
    v_exp_f32 v88, v88
    v_dot2_f32_bf16 v21, v66, s100, 0
    ds_read_b128 v[8:11], v5 offset:0
    v_exp_f32 v89, v89
    v_cvt_pk_bf16_f32 v82, v80, v81
    v_exp_f32 v96, v96
    v_exp_f32 v97, v97
    v_dot2_f32_bf16 v21, v74, s100, v21
    v_cvt_pk_bf16_f32 v90, v88, v89
    v_exp_f32 v104, v104
    v_exp_f32 v105, v105
    v_dot2_f32_bf16 v21, v82, s100, v21
    v_cvt_pk_bf16_f32 v98, v96, v97
    v_exp_f32 v112, v112
    v_exp_f32 v113, v113
    v_dot2_f32_bf16 v21, v90, s100, v21
    v_cvt_pk_bf16_f32 v106, v104, v105
    v_exp_f32 v120, v120
    v_exp_f32 v121, v121
    v_dot2_f32_bf16 v21, v98, s100, v21
    v_cvt_pk_bf16_f32 v114, v112, v113
    v_dot2_f32_bf16 v21, v106, s100, v21
    v_cvt_pk_bf16_f32 v122, v120, v121
    v_dot2_f32_bf16 v21, v114, s100, v21
    v_dot2_f32_bf16 v21, v122, s100, v21
    s_waitcnt lgkmcnt(0)
    v_smfmac_f32_16x16x64_bf16 v[24:27], v[8:11], v[128:135], v56
    ds_write2st64_b32 v23, v82, v90 offset0:2 offset1:3
    v_add_f32_dpp v21, v21, v21 row_ror:1 row_mask:0xf bank_mask:0xf
    v_smfmac_f32_16x16x64_bf16 v[28:31], v[8:11], v[136:143], v56
    s_nop 0
    v_add_f32_dpp v21, v21, v21 row_ror:2 row_mask:0xf bank_mask:0xf
    v_smfmac_f32_16x16x64_bf16 v[32:35], v[8:11], v[144:151], v56
    ds_read_b128 v[12:15], v5 offset:512
    v_add_f32_dpp v21, v21, v21 row_ror:4 row_mask:0xf bank_mask:0xf
    v_smfmac_f32_16x16x64_bf16 v[36:39], v[8:11], v[152:159], v56
    ds_write2st64_b32 v23, v98, v106 offset0:4 offset1:5
    v_add_f32_dpp v21, v21, v21 row_ror:8 row_mask:0xf bank_mask:0xf
    v_smfmac_f32_16x16x64_bf16 v[40:43], v[8:11], v[160:167], v56
    buffer_store_dwordx2 v[20:21], v6, s[40:43], s70 offen
    buffer_store_dwordx2 v[20:21], v6, s[44:47], s70 offen sc1
    v_smfmac_f32_16x16x64_bf16 v[44:47], v[8:11], v[168:175], v56
    ds_write2st64_b32 v23, v114, v122 offset0:6 offset1:7
    v_smfmac_f32_16x16x64_bf16 v[48:51], v[8:11], v[176:183], v56
    ds_read_b64_tr_b16 v[64:65], v2 offset:0
    v_smfmac_f32_16x16x64_bf16 v[52:55], v[8:11], v[184:191], v56
    ds_read_b64_tr_b16 v[66:67], v2 offset:512
    ds_read_b64_tr_b16 v[72:73], v57 offset:0
    s_waitcnt lgkmcnt(5)
    s_nop 0
    v_smfmac_f32_16x16x64_bf16 v[24:27], v[12:15], v[192:199], v56
    ds_read_b128 v[8:11], v5 offset:1024
    v_smfmac_f32_16x16x64_bf16 v[28:31], v[12:15], v[200:207], v56
    ds_read_b64_tr_b16 v[74:75], v57 offset:512
    ds_read_b64_tr_b16 v[80:81], v58 offset:0
    v_smfmac_f32_16x16x64_bf16 v[32:35], v[12:15], v[208:215], v56
    ds_read_b64_tr_b16 v[82:83], v58 offset:512
    ds_read_b64_tr_b16 v[88:89], v59 offset:0
    v_smfmac_f32_16x16x64_bf16 v[36:39], v[12:15], v[216:223], v56
    ds_read_b64_tr_b16 v[90:91], v59 offset:512
    ds_read_b64_tr_b16 v[96:97], v60 offset:0
    v_smfmac_f32_16x16x64_bf16 v[40:43], v[12:15], v[224:231], v56
    ds_read_b64_tr_b16 v[98:99], v60 offset:512
    ds_read_b64_tr_b16 v[104:105], v61 offset:0
    v_smfmac_f32_16x16x64_bf16 v[44:47], v[12:15], v[232:239], v56
    ds_read_b64_tr_b16 v[106:107], v61 offset:512
    ds_read_b64_tr_b16 v[112:113], v62 offset:0
    v_smfmac_f32_16x16x64_bf16 v[48:51], v[12:15], v[240:247], v56
    ds_read_b64_tr_b16 v[114:115], v62 offset:512
    ds_read_b64_tr_b16 v[120:121], v63 offset:0
    v_smfmac_f32_16x16x64_bf16 v[52:55], v[12:15], v[248:255], v56
    ds_read_b64_tr_b16 v[122:123], v63 offset:512
    s_waitcnt lgkmcnt(13)
    v_smfmac_f32_16x16x64_bf16 v[24:27], v[8:11], a[0:7], v56
    s_nop 0
    ds_read_b128 v[12:15], v5 offset:1536
    v_smfmac_f32_16x16x64_bf16 v[28:31], v[8:11], a[8:15], v56
    buffer_load_dwordx4 v[128:131], v1, s[36:39], s71 offen offset:0 sc1
    v_smfmac_f32_16x16x64_bf16 v[32:35], v[8:11], a[16:23], v56
    v_smfmac_f32_16x16x64_bf16 v[36:39], v[8:11], a[24:31], v56
    v_smfmac_f32_16x16x64_bf16 v[40:43], v[8:11], a[32:39], v56
    v_smfmac_f32_16x16x64_bf16 v[44:47], v[8:11], a[40:47], v56
    v_smfmac_f32_16x16x64_bf16 v[48:51], v[8:11], a[48:55], v56
    buffer_load_dwordx4 v[128:131], v1, s[36:39], s71 offen offset:0 sc1
    v_smfmac_f32_16x16x64_bf16 v[52:55], v[8:11], a[56:63], v56
    s_waitcnt lgkmcnt(0)
    v_smfmac_f32_16x16x64_bf16 v[24:27], v[12:15], v[64:71], v56
    s_nop 0
    v_smfmac_f32_16x16x64_bf16 v[28:31], v[12:15], v[72:79], v56
    v_smfmac_f32_16x16x64_bf16 v[32:35], v[12:15], v[80:87], v56
    v_smfmac_f32_16x16x64_bf16 v[36:39], v[12:15], v[88:95], v56
    v_smfmac_f32_16x16x64_bf16 v[40:43], v[12:15], v[96:103], v56
    v_smfmac_f32_16x16x64_bf16 v[44:47], v[12:15], v[104:111], v56
    v_smfmac_f32_16x16x64_bf16 v[48:51], v[12:15], v[112:119], v56
    s_waitcnt lgkmcnt(0)
L_ml2_53_w:
    s_waitcnt vmcnt(1)
    v_max3_u32 v6, v128, v129, v130
    v_max_u32 v6, v6, v131
    v_cmp_lt_u32 vcc, s95, v6
    v_sub_f32 v58, v128, v20
    v_sub_f32 v59, v130, v20
    v_exp_f32 v58, v58
    s_cbranch_vccnz L_ml2_53
    v_exp_f32 v59, v59
    v_mul_f32 v7, v58, v129
    v_fmac_f32_e64 v7, v59, v131
    v_smfmac_f32_16x16x64_bf16 v[52:55], v[12:15], v[120:127], v56
    s_nop 0
    v_add_f32_dpp v7, v7, v7 row_ror:1 row_mask:0xf bank_mask:0xf
    v_add_f32 v8, v24, v25
    v_add_f32_e64 v9, v28, v29
    v_add_f32_dpp v7, v7, v7 row_ror:2 row_mask:0xf bank_mask:0xf
    v_add_f32 v10, v32, v33
    v_add_f32 v11, v36, v37
    v_add_f32_dpp v7, v7, v7 row_ror:4 row_mask:0xf bank_mask:0xf
    v_add_f32 v60, v40, v41
    v_add_f32 v61, v44, v45
    v_add_f32_dpp v7, v7, v7 row_ror:8 row_mask:0xf bank_mask:0xf
    v_rcp_f32 v7, v7
    v_add_f32 v62, v48, v49
    v_pk_mul_f32 v[8:9], v[8:9], v[6:7] op_sel:[0,1] op_sel_hi:[1,1]
    v_pk_mul_f32 v[10:11], v[10:11], v[6:7] op_sel:[0,1] op_sel_hi:[1,1]
    v_add_f32_e64 v63, v52, v53
    v_pk_mul_f32 v[60:61], v[60:61], v[6:7] op_sel:[0,1] op_sel_hi:[1,1]
    v_pk_mul_f32 v[62:63], v[62:63], v[6:7] op_sel:[0,1] op_sel_hi:[1,1]
    ds_write_b128 v22, v[8:11] offset:0
    ds_write_b128 v22, v[60:63] offset:256
    s_branch L_tail
L_ml2_53:
    buffer_load_dwordx4 v[128:131], v1, s[36:39], s71 offen offset:0 sc1
    s_add_u32 s94, s94, 1
    s_cmp_lt_u32 s94, 0x40000
    s_cselect_b32 s95, -2, -1
    s_branch L_ml2_53_w
L_last:
    s_lshr_b32 s100, s62, 2
    s_xor_b32 s100, s100, s61
    s_or_b32 s100, s100, s60
    s_cmp_eq_u32 s100, 0
    s_cbranch_scc0 L_fin
    v_lshrrev_b32 v28, 5, v0
    v_lshlrev_b32 v28, 10, v28
    v_bfe_u32 v7, v0, 4, 1
    v_lshl_add_u32 v28, v7, 11, v28
    v_and_b32 v7, 15, v0
    v_lshl_add_u32 v28, v7, 1, v28
    v_and_b32 v7, 1, v0
    v_cmp_eq_u32 vcc, 0, v7
    v_mov_b32 v7, 0x7fff0000
    s_nop 0
    v_cndmask_b32 v28, v7, v28, vcc
    s_mov_b32 s40, s48
    s_mov_b32 s41, s49
    s_mov_b32 s42, 4096
    s_mov_b32 s43, 0x20000
    s_lshl_b32 s3, s62, 5
    s_waitcnt vmcnt(0)
    buffer_load_dwordx4 v[8:11], v1, s[24:27], s68 offen offset:0 sc1
    buffer_load_dwordx4 v[12:15], v1, s[24:27], s68 offen offset:1024 sc1
    buffer_load_dwordx4 v[16:19], v1, s[24:27], s68 offen offset:2048 sc1
    buffer_load_dwordx4 v[20:23], v1, s[24:27], s68 offen offset:3072 sc1
    s_branch L_redd
L_out:
L_fin:
L_end:
    s_endpgm
L_slow1:
    buffer_store_dword v14, v15, s[44:47], s100 offen sc1
    s_branch L_slow1_b
L_slow2:
    buffer_store_dword v16, v10, s[44:47], s100 offen sc1
    s_branch L_slow2_b
L_slow3:
    buffer_store_dword v9, v6, s[44:47], s84 offen sc1
    s_branch L_slow3_b
L_slow4:
    buffer_store_dwordx4 v[20:23], v24, s[44:47], s100 offen sc1
    s_branch L_slow4_b
L_slow5:
    buffer_store_dword v14, v15, s[44:47], s100 offen sc1
    s_nop 0
    s_branch L_slow5_b
L_slow6:
    buffer_store_dword v20, v10, s[44:47], s100 offen sc1
    s_branch L_slow6_b
L_slow7:
    buffer_store_dwordx4 v[80:83], v88, s[44:47], s100 offen sc1
    s_branch L_slow7_b
L_slow8:
    buffer_store_dwordx4 v[80:83], v90, s[44:47], s100 offen sc1
    s_branch L_slow8_b
L_slow9:
    buffer_store_dword v7, v17, s[44:47], s72 offen sc1
    s_branch L_slow9_b
L_nored1:
    s_lshl2_add_u32 s100, s69, s60
    s_cmp_eq_u32 s100, 5
    s_cbranch_scc0 L_nof2
    v_mov_b32 v64, -1
    v_mov_b32 v65, -1
    v_mov_b32 v66, -1
    v_mov_b32 v67, -1
    v_lshrrev_b32 v72, 4, v0
    v_lshlrev_b32_e64 v72, 15, v72
    v_bfe_u32 v73, v0, 3, 1
    v_lshl_add_u32 v72, v73, 13, v72
    v_and_b32 v73, 7, v0
    v_lshl_add_u32 v72, v73, 4, v72
    s_lshl_b32 s100, s64, 17
    s_lshl_b32 s101, s61, 9
    s_add_u32 s100, s100, s101
    s_lshl_b32 s101, s63, 7
    s_add_u32 s100, s100, s101
    s_add_u32 s100, s100, 0x4000
    buffer_store_dwordx4 v[64:67], v72, s[24:27], s100 offen sc1
L_nof2:
    s_waitcnt vmcnt(0)
    s_branch L_red1
L_slow10:
    buffer_store_dword v7, v122, s[44:47], s76 offen sc1
    s_branch L_slow10_b
L_slow11:
    buffer_store_dword v5, v121, s[44:47], s3 offen sc1
    s_branch L_slow11_b
L_slow12:
    buffer_store_dword v6, v120, s[44:47], s78 offen sc1
    s_branch L_slow12_b
L_fill3:
    s_cmp_eq_u32 s60, 1
    s_cbranch_scc0 L_nored2
    v_mov_b32 v16, -1
    v_mov_b32 v17, -1
    v_mov_b32 v18, -1
    v_mov_b32_e64 v19, -1
    v_lshrrev_b32_e64 v20, 4, v0
    v_lshlrev_b32_e64 v20, 15, v20
    v_bfe_u32 v21, v0, 3, 1
    v_lshl_add_u32 v20, v21, 13, v20
    v_and_b32 v21, 7, v0
    v_lshl_add_u32 v20, v21, 4, v20
    s_lshl_b32 s100, s64, 17
    s_lshl_b32 s101, s61, 9
    s_add_u32 s100, s100, s101
    s_lshl_b32 s101, s63, 7
    s_add_u32 s100, s100, s101
    s_add_u32 s100, s100, 0x5000
    buffer_store_dwordx4 v[16:19], v20, s[24:27], s100 offen sc1
    s_branch L_nored2
L_slow13:
    buffer_store_dword v7, v28, s[44:47], s3 offen sc1
    s_branch L_slow13_b
L_slow14:
    buffer_store_dword v26, v30, s[44:47], s87 offen sc1
    s_branch L_slow14_b
L_slow15:
    buffer_store_dword v10, v29, s[44:47], s84 offen sc1
    s_branch L_slow15_b
L_codeend:
.section .rodata,"a"
.p2align 6
.amdhsa_kernel interleave_layers__gqa_block_cached__glu_gated_bilinear__decode_kernel
  .amdhsa_next_free_vgpr 512
  .amdhsa_next_free_sgpr 102
  .amdhsa_accum_offset 256
  .amdhsa_group_segment_fixed_size 0
  .amdhsa_kernarg_size 96
  .amdhsa_user_sgpr_count 2
  .amdhsa_user_sgpr_kernarg_segment_ptr 1
  .amdhsa_system_sgpr_workgroup_id_x 1
.end_amdhsa_kernel
```
